```python
import torch

def _softmax(x, axis=-1):
    return torch.softmax(x, dim=axis)
def _gelu(x):
    return torch.nn.functional.gelu(x, approximate="tanh")
def _silu(x):
    return torch.nn.functional.silu(x)
def _sigmoid(x):
    return torch.sigmoid(x)
def _layernorm(x, axis=-1, eps=1e-5):
    m = x.mean(dim=axis, keepdim=True)
    v = x.var(dim=axis, keepdim=True, unbiased=False)
    return (x - m) / torch.sqrt(v + eps)
def _scatter_add(tgt, idx, src, axis=0):
    return tgt.clone().index_add_(axis, idx, src)
def _segment_sum(src, seg, n):
    out = torch.zeros((n,) + src.shape[1:], dtype=src.dtype)
    return out.index_add_(0, seg, src)
def _pad(x, pw):
    flat = tuple(v for pair in reversed(pw) for v in pair)
    return torch.nn.functional.pad(x, flat)

kernel_name = 'concat_heads__softmax_full_mha__spectral_fnet__prompt'

def setup_inputs():

    _w = (lambda a: (lambda t: t.to(torch.bfloat16) if t.is_floating_point() else t)(torch.as_tensor(a)))
    def _A_setup():
        B, S, D = 1, 2048, 448
        return {
            "x": _w((lambda *s: torch.randn(*s, dtype=torch.bfloat16) * 0.2)(B, S, D)),
            "wqkv": _w((lambda *s: torch.randn(*s, dtype=torch.bfloat16) * 0.8)(D, 3 * D)),
            "wo": _w((lambda *s: torch.randn(*s, dtype=torch.bfloat16) * 0.2)(D, D)),
        }
    _A_in = _A_setup()

    def _B_setup():
        B, S, D = 1, 2048, 448
        ns = torch.arange(S)[:, None] * torch.arange(S)[None, :]
        nd = torch.arange(D)[:, None] * torch.arange(D)[None, :]
        Ws_re = torch.cos(-2.0 * torch.pi * ns / S).to(float)
        Ws_im = torch.sin(-2.0 * torch.pi * ns / S).to(float)
        Wd_re = torch.cos(-2.0 * torch.pi * nd / D).to(float)
        Wd_im = torch.sin(-2.0 * torch.pi * nd / D).to(float)
        return {
            "x": _w((lambda *s: torch.randn(*s, dtype=torch.bfloat16) * 0.05)(B, S, D)),
            "dft_seq_re": _w(Ws_re),
            "dft_seq_im": _w(Ws_im),
            "dft_hid_re": _w(Wd_re),
            "dft_hid_im": _w(Wd_im),
        }
    _B_in = _B_setup()

    return {
        "A_x": _A_in["x"],
        "A_wqkv": _A_in["wqkv"],
        "A_wo": _A_in["wo"],
        "B_x": _B_in["x"],
        "B_dft_seq_re": _B_in["dft_seq_re"],
        "B_dft_seq_im": _B_in["dft_seq_im"],
        "B_dft_hid_re": _B_in["dft_hid_re"],
        "B_dft_hid_im": _B_in["dft_hid_im"],
    }

def reference(A_x, A_wqkv, A_wo, B_x, B_dft_seq_re, B_dft_seq_im, B_dft_hid_re, B_dft_hid_im):
    def _A_ref(x, wqkv, wo):
        B, S, D = x.shape
        H = 16; Dh = D // H
        qkv = (lambda x, *d: x.permute(*d))((x @ wqkv).reshape(B, S, 3, H, Dh), 2, 0, 3, 1, 4)
        q, k, v = qkv[0], qkv[1], qkv[2]
        scale = Dh ** -0.5
        scores = torch.einsum("bhqd,bhkd->bhqk", q, k) * scale
        p = _softmax(scores, axis=-1)
        o = torch.einsum("bhqk,bhkd->bhqd", p, v)
        return (lambda x, *d: x.permute(*d))(o, 0, 2, 1, 3).reshape(B, S, D) @ wo

    def _B_ref(x, dft_seq_re, dft_seq_im, dft_hid_re, dft_hid_im):
        a = torch.einsum("bsd,ed->bse", x, dft_hid_re)
        b = torch.einsum("bsd,ed->bse", x, dft_hid_im)
        y = torch.einsum("ts,bse->bte", dft_seq_re, a) - torch.einsum("ts,bse->bte", dft_seq_im, b)
        return y

    a = _A_ref(A_x, A_wqkv, A_wo)
    b = _B_ref(B_x, B_dft_seq_re, B_dft_seq_im, B_dft_hid_re, B_dft_hid_im)
    return torch.concatenate([a, b], axis=-1)
```

```asm
; @launch kernel=main_kernel grid=(512,1,1) block=(512,1,1) lds=81920
.amdgcn_target "amdgcn-amd-amdhsa--gfx950"
.text
.globl main_kernel
.p2align 8
.type main_kernel,@function
main_kernel:
    s_cmp_ge_u32 s2, 512
    s_cbranch_scc1 M_done

    s_load_dwordx16 s[64:79], s[0:1], 0
    s_load_dwordx2 s[80:81], s[0:1], 64
    s_memrealtime s[84:85]
    s_load_dwordx2 s[24:25], s[0:1], 80
    v_and_b32 v1, 63, v0
    v_lshrrev_b32 v2, 6, v0
    s_mov_b32 s83, 0
    v_readfirstlane_b32 s10, v2
    v_lshlrev_b32 v5, 4, v1
    s_mov_b32 s26, 0x10000000
    s_mov_b32 s27, 0x00020000

    s_mov_b32 s82, s2
    s_waitcnt lgkmcnt(0)
    s_mov_b32 s3, s82
    s_cmp_ge_u32 s82, 256
    s_cbranch_scc1 ROLE_B

    s_setprio 1
    s_cmp_ge_u32 s82, 224
    s_cbranch_scc1 A_ATT
    s_mov_b32 s2, s82

QKV_ENTRY:
    s_mov_b32 s3, s2
    s_mov_b64 s[4:5], s[64:65]
    s_mov_b64 s[6:7], s[66:67]

    s_and_b32 s11, s2, 31
    s_lshr_b32 s12, s2, 5
    s_and_b32 s13, s10, 1
    s_lshr_b32 s14, s10, 1
    s_cmp_ge_u32 s10, 6
    s_cselect_b32 s16, s4, s6
    s_cselect_b32 s17, s5, s7
    s_mov_b32 s18, 1204224
    s_cmov_b32 s18, 1835008
    s_mov_b32 s19, 0x00020000
    s_mov_b32 s20, 2688
    s_cmov_b32 s20, 896
    s_cselect_b32 s21, 3, 1
    s_cselect_b32 s22, 0, 1

    s_lshl_b32 s28, s10, 1
    s_add_u32 s28, s28, 0
    s_mul_i32 s29, s28, 11
    s_lshr_b32 s29, s29, 5
    s_mul_i32 s30, s29, 3
    s_sub_u32 s30, s28, s30
    s_and_b32 s31, s29, 1
    s_lshl_b32 s44, s31, 2
    s_mul_i32 s29, s29, 21504
    s_lshl_b32 s30, s30, 7
    s_add_u32 s29, s29, s30
    s_mul_i32 s30, s12, 384
    s_add_u32 s46, s29, s30
    s_lshl_b32 s29, s11, 6
    s_sub_u32 s30, s10, 6
    s_lshl_b32 s30, s30, 4
    s_add_u32 s29, s29, s30
    s_add_u32 s29, s29, 0
    s_mul_i32 s29, s29, 896
    s_cmp_ge_u32 s10, 6
    s_cmov_b32 s44, 0
    s_cmov_b32 s46, s29

    s_lshl_b32 s28, s10, 1
    s_add_u32 s28, s28, 1
    s_mul_i32 s29, s28, 11
    s_lshr_b32 s29, s29, 5
    s_mul_i32 s30, s29, 3
    s_sub_u32 s30, s28, s30
    s_and_b32 s31, s29, 1
    s_lshl_b32 s45, s31, 2
    s_mul_i32 s29, s29, 21504
    s_lshl_b32 s30, s30, 7
    s_add_u32 s29, s29, s30
    s_mul_i32 s30, s12, 384
    s_add_u32 s47, s29, s30
    s_lshl_b32 s29, s11, 6
    s_sub_u32 s30, s10, 6
    s_lshl_b32 s30, s30, 4
    s_add_u32 s29, s29, s30
    s_add_u32 s29, s29, 8
    s_mul_i32 s29, s29, 896
    s_cmp_ge_u32 s10, 6
    s_cmov_b32 s45, 4
    s_cmov_b32 s47, s29

    v_lshrrev_b32 v6, 3, v1
    v_mul_lo_u32 v6, v6, s20
    v_lshrrev_b32 v7, 4, v1
    v_and_b32 v7, s21, v7
    v_lshlrev_b32 v7, s22, v7
    v_and_b32 v8, 7, v1
    v_xor_b32 v7, v7, v8
    v_xor_b32 v8, s44, v7
    v_xor_b32 v9, s45, v7
    v_lshl_add_u32 v8, v8, 4, v6
    v_lshl_add_u32 v9, v9, 4, v6
    v_add_u32 v8, s46, v8
    v_add_u32 v9, s47, v9
    s_lshl_b32 s28, s10, 11
    s_sub_u32 s29, s10, 6
    s_lshl_b32 s29, s29, 11
    s_add_u32 s29, s29, 49152
    s_cmp_ge_u32 s10, 6
    s_cmov_b32 s28, s29

    s_lshr_b32 s29, s11, 3
    s_lshl_b32 s29, s29, 1
    s_add_u32 s29, s29, s12
    s_cmp_ge_u32 s29, 7
    s_cselect_b32 s30, 7, 0
    s_sub_u32 s29, s29, s30
    s_mul_i32 s29, s29, 1
    s_mul_i32 s48, s29, 172032
    s_lshl_b32 s29, s29, 7
    s_mov_b32 s49, 86016
    s_mov_b32 s50, 86016
    s_mov_b32 s51, 1204224
    s_cmp_ge_u32 s10, 6
    s_cmov_b32 s48, s29
    s_cmov_b32 s49, 28672
    s_cmov_b32 s50, 4294938752
    s_cmov_b32 s51, 896

    s_cmp_lt_u32 s10, 6
    s_cbranch_scc1 QKV_nox

    s_cmp_ge_u32 s10, 6
    s_mov_b32 s29, 0
    s_cmov_b32 s29, 0
    s_add_u32 m0, s29, s28
    s_add_u32 s29, s29, s28
    buffer_load_dwordx4 v8, s[16:19], s48 offen lds
    s_add_u32 m0, s29, 1024
    s_nop 0
    buffer_load_dwordx4 v9, s[16:19], s48 offen lds
    s_add_u32 s48, s48, s49
    s_cmp_eq_u32 s48, s51
    s_cmov_b32 s48, 0

QKV_nox:
    s_cmp_ge_u32 s10, 6
    s_mov_b32 s29, 0
    s_cmov_b32 s29, 4096
    s_add_u32 m0, s29, s28
    s_add_u32 s29, s29, s28
    buffer_load_dwordx4 v8, s[16:19], s48 offen lds
    s_add_u32 m0, s29, 1024
    s_nop 0
    buffer_load_dwordx4 v9, s[16:19], s48 offen lds
    s_add_u32 s48, s48, s50
    s_cmp_eq_u32 s48, s51
    s_cmov_b32 s48, 0

    s_cmp_ge_u32 s10, 6
    s_mov_b32 s29, 12288
    s_cmov_b32 s29, 8192
    s_add_u32 m0, s29, s28
    s_add_u32 s29, s29, s28
    buffer_load_dwordx4 v8, s[16:19], s48 offen lds
    s_add_u32 m0, s29, 1024
    s_nop 0
    buffer_load_dwordx4 v9, s[16:19], s48 offen lds
    s_add_u32 s48, s48, s49
    s_cmp_eq_u32 s48, s51
    s_cmov_b32 s48, 0

    s_cmp_ge_u32 s10, 6
    s_mov_b32 s29, 24576
    s_cmov_b32 s29, 12288
    s_add_u32 m0, s29, s28
    s_add_u32 s29, s29, s28
    buffer_load_dwordx4 v8, s[16:19], s48 offen lds
    s_add_u32 m0, s29, 1024
    s_nop 0
    buffer_load_dwordx4 v9, s[16:19], s48 offen lds
    s_add_u32 s48, s48, s50
    s_cmp_eq_u32 s48, s51
    s_cmov_b32 s48, 0

    v_and_b32 v3, 15, v1
    v_lshrrev_b32 v4, 4, v1
    v_bfe_u32 v6, v1, 1, 3
    v_xor_b32 v6, v6, v4
    v_lshlrev_b32 v6, 4, v6
    v_lshl_add_u32 v6, v3, 7, v6
    s_lshl_b32 s29, s13, 12
    s_add_u32 s29, s29, 49152
    v_add_u32 v10, s29, v6
    v_xor_b32 v11, 64, v10
    v_mul_u32_u24 v6, 3072, v4
    v_lshrrev_b32 v7, 2, v3
    v_lshl_add_u32 v6, v7, 7, v6
    v_and_b32 v7, 1, v3
    v_lshl_add_u32 v6, v7, 3, v6
    v_bfe_u32 v7, v3, 1, 1
    v_bfe_u32 v15, v3, 3, 1
    v_lshl_add_u32 v7, v15, 1, v7
    v_and_b32 v15, 1, v4
    v_lshl_add_u32 v7, v15, 2, v7

    s_mul_i32 s29, s14, 96
    s_add_u32 s29, s29, 0
    s_lshr_b32 s30, s29, 7
    s_lshl_b32 s30, s30, 10
    s_lshr_b32 s29, s29, 4
    s_and_b32 s29, s29, 6
    v_xor_b32 v15, s29, v7
    v_lshl_add_u32 v15, v15, 4, v6
    v_add_u32 v12, s30, v15

    s_mul_i32 s29, s14, 96
    s_add_u32 s29, s29, 32
    s_lshr_b32 s30, s29, 7
    s_lshl_b32 s30, s30, 10
    s_lshr_b32 s29, s29, 4
    s_and_b32 s29, s29, 6
    v_xor_b32 v15, s29, v7
    v_lshl_add_u32 v15, v15, 4, v6
    v_add_u32 v13, s30, v15

    s_mul_i32 s29, s14, 96
    s_add_u32 s29, s29, 64
    s_lshr_b32 s30, s29, 7
    s_lshl_b32 s30, s30, 10
    s_lshr_b32 s29, s29, 4
    s_and_b32 s29, s29, 6
    v_xor_b32 v15, s29, v7
    v_lshl_add_u32 v15, v15, 4, v6
    v_add_u32 v14, s30, v15

    s_mul_i32 s36, s12, 192
    s_mul_i32 s37, s36, 293
    s_lshr_b32 s37, s37, 13
    s_mul_i32 s35, s37, 28
    s_add_u32 s38, s35, 28
    s_cmp_le_u32 s38, s36
    s_cselect_b32 s38, 1, 0
    s_cmp_gt_u32 s35, s36
    s_cselect_b32 s35, 1, 0
    s_add_u32 s37, s37, s38
    s_sub_u32 s37, s37, s35
    s_add_u32 s38, s37, s10
    s_mul_i32 s39, s38, 28
    s_sub_u32 s40, s36, s39
    s_add_u32 s41, s40, 192
    s_lshl_b32 s29, s10, 12
    s_lshr_b32 s30, s10, 2
    s_lshl_b32 s30, s30, 14
    s_add_u32 s29, s29, s30
    s_add_u32 s29, s29, 24576
    v_add_u32 v83, s29, v5
    s_lshl_b32 s42, s38, 17
    s_lshl_b32 s31, s11, 12
    s_add_u32 s42, s42, s31
    s_and_b32 s29, s38, 15
    s_mov_b32 s30, 8
    s_mov_b32 s31, 16
    s_mov_b32 s43, 24
    s_cmp_eq_u32 s29, 13
    s_cmov_b32 s31, 20
    s_cmov_b32 s43, 16
    s_cmp_eq_u32 s29, 11
    s_cmov_b32 s30, 12
    s_cmov_b32 s31, 20
    s_cmov_b32 s43, 8
    v_cmp_le_u32 vcc, 32, v1
    v_mov_b32 v6, s30
    v_cndmask_b32 v6, 0, v6, vcc
    v_mov_b32 v7, s31
    v_mov_b32 v15, s43
    v_cndmask_b32 v7, v7, v15, vcc
    s_cmp_lt_u32 s38, 32
    s_cbranch_scc1 QKV_cqk
    v_and_b32 v6, 0x13, v1
    v_bfe_u32 v7, v1, 2, 1
    v_lshl_add_u32 v6, v7, 3, v6
    v_bfe_u32 v7, v1, 3, 1
    v_lshl_add_u32 v6, v7, 2, v6
    v_min_u32 v6, 24, v6
    v_mov_b32 v7, v6

QKV_cqk:
    v_cmp_le_i32 vcc, s40, v6
    v_cmp_gt_i32 s[32:33], s41, v6
    s_and_b64 s[32:33], s[32:33], vcc

    v_cmp_le_i32 vcc, s40, v7
    v_cmp_gt_i32 s[34:35], s41, v7
    s_and_b64 s[34:35], s[34:35], vcc

    s_lshl_b32 s29, s13, 11
    s_add_u32 s29, s29, 24576
    v_lshlrev_b32 v6, 4, v3
    v_add_u32 v6, s29, v6
    v_and_b32 v7, 1, v4
    v_lshlrev_b32 v7, 9, v7
    v_lshrrev_b32 v15, 1, v4
    v_lshl_add_u32 v7, v15, 3, v7
    v_add_u32 v7, s29, v7
    v_mov_b32 v96, 0x3f803f80
    v_mov_b32 v97, 0x3f803f80

    s_mul_i32 s15, s12, 192
    s_mul_i32 s29, s14, 48
    s_add_u32 s15, s15, s29
    s_cmp_ge_u32 s15, 896
    s_cbranch_scc1 QKV_v3
    s_cmp_ge_u32 s15, 864
    s_cbranch_scc1 QKV_v1

    s_add_u32 s29, s15, 0
    s_cmp_ge_u32 s29, 448
    s_cselect_b32 s58, 1.0, 0x3e8b97f6
    s_cselect_b32 s30, 0x3f80, 0
    s_lshr_b32 s29, s29, 2
    v_add_u32 v84, s29, v4
    v_mul_u32_u24 v85, 293, v84
    v_lshrrev_b32 v85, 11, v85
    v_mul_u32_u24 v86, 7, v85
    v_sub_u32 v84, v84, v86
    v_and_b32 v86, 15, v85
    v_mov_b32 v87, 6
    v_cmp_eq_u32 vcc, 13, v86
    v_cndmask_b32 v87, v87, 4, vcc
    v_cmp_eq_u32 vcc, 11, v86
    v_cndmask_b32 v87, v87, 2, vcc
    v_cmp_eq_u32 s[52:53], v84, v87
    v_cmp_gt_u32 vcc, v84, v87
    v_subrev_u32 v86, 1, v84
    v_cndmask_b32 v84, v84, v86, vcc
    v_cndmask_b32 v84, v84, 6, s[52:53]
    v_subrev_u32 v85, s37, v85
    v_lshrrev_b32 v86, 2, v85
    v_lshl_add_u32 v85, v85, 12, v6
    v_lshl_add_u32 v85, v86, 14, v85
    v_lshrrev_b32 v86, 1, v84
    v_lshl_add_u32 v85, v86, 9, v85
    v_and_b32 v86, 1, v84
    v_lshl_add_u32 v80, v86, 3, v85
    v_mov_b32 v90, s30
    v_mov_b32 v91, 0

    s_add_u32 s29, s15, 16
    s_cmp_ge_u32 s29, 448
    s_cselect_b32 s59, 1.0, 0x3e8b97f6
    s_cselect_b32 s30, 0x3f80, 0
    s_lshr_b32 s29, s29, 2
    v_add_u32 v84, s29, v4
    v_mul_u32_u24 v85, 293, v84
    v_lshrrev_b32 v85, 11, v85
    v_mul_u32_u24 v86, 7, v85
    v_sub_u32 v84, v84, v86
    v_and_b32 v86, 15, v85
    v_mov_b32 v87, 6
    v_cmp_eq_u32 vcc, 13, v86
    v_cndmask_b32 v87, v87, 4, vcc
    v_cmp_eq_u32 vcc, 11, v86
    v_cndmask_b32 v87, v87, 2, vcc
    v_cmp_eq_u32 s[54:55], v84, v87
    v_cmp_gt_u32 vcc, v84, v87
    v_subrev_u32 v86, 1, v84
    v_cndmask_b32 v84, v84, v86, vcc
    v_cndmask_b32 v84, v84, 6, s[54:55]
    v_subrev_u32 v85, s37, v85
    v_lshrrev_b32 v86, 2, v85
    v_lshl_add_u32 v85, v85, 12, v6
    v_lshl_add_u32 v85, v86, 14, v85
    v_lshrrev_b32 v86, 1, v84
    v_lshl_add_u32 v85, v86, 9, v85
    v_and_b32 v86, 1, v84
    v_lshl_add_u32 v81, v86, 3, v85
    v_mov_b32 v92, s30
    v_mov_b32 v93, 0

    s_add_u32 s29, s15, 32
    s_cmp_ge_u32 s29, 448
    s_cselect_b32 s60, 1.0, 0x3e8b97f6
    s_cselect_b32 s30, 0x3f80, 0
    s_lshr_b32 s29, s29, 2
    v_add_u32 v84, s29, v4
    v_mul_u32_u24 v85, 293, v84
    v_lshrrev_b32 v85, 11, v85
    v_mul_u32_u24 v86, 7, v85
    v_sub_u32 v84, v84, v86
    v_and_b32 v86, 15, v85
    v_mov_b32 v87, 6
    v_cmp_eq_u32 vcc, 13, v86
    v_cndmask_b32 v87, v87, 4, vcc
    v_cmp_eq_u32 vcc, 11, v86
    v_cndmask_b32 v87, v87, 2, vcc
    v_cmp_eq_u32 s[56:57], v84, v87
    v_cmp_gt_u32 vcc, v84, v87
    v_subrev_u32 v86, 1, v84
    v_cndmask_b32 v84, v84, v86, vcc
    v_cndmask_b32 v84, v84, 6, s[56:57]
    v_subrev_u32 v85, s37, v85
    v_lshrrev_b32 v86, 2, v85
    v_lshl_add_u32 v85, v85, 12, v6
    v_lshl_add_u32 v85, v86, 14, v85
    v_lshrrev_b32 v86, 1, v84
    v_lshl_add_u32 v85, v86, 9, v85
    v_and_b32 v86, 1, v84
    v_lshl_add_u32 v82, v86, 3, v85
    v_mov_b32 v94, s30
    v_mov_b32 v95, 0

    s_waitcnt vmcnt(4) lgkmcnt(0)
    s_barrier
    ds_read_b128 v[40:43], v10 offset:0
    ds_read_b128 v[44:47], v10 offset:2048
    ds_read_b64_tr_b16 v[48:49], v12 offset:0
    ds_read_b64_tr_b16 v[50:51], v12 offset:512
    ds_read_b64_tr_b16 v[52:53], v13 offset:0
    ds_read_b64_tr_b16 v[54:55], v13 offset:512
    ds_read_b64_tr_b16 v[56:57], v14 offset:0
    ds_read_b64_tr_b16 v[58:59], v14 offset:512
    s_cmp_ge_u32 s10, 6
    s_mov_b32 s29, 36864
    s_cmov_b32 s29, 16384
    s_add_u32 m0, s29, s28
    s_add_u32 s29, s29, s28
    buffer_load_dwordx4 v8, s[16:19], s48 offen lds
    s_add_u32 m0, s29, 1024
    s_nop 0
    buffer_load_dwordx4 v9, s[16:19], s48 offen lds
    s_add_u32 s48, s48, s49
    s_cmp_eq_u32 s48, s51
    s_cmov_b32 s48, 0

    s_waitcnt vmcnt(4) lgkmcnt(0)
    s_barrier
    ds_read_b128 v[60:63], v11 offset:0
    ds_read_b128 v[64:67], v11 offset:2048
    ds_read_b64_tr_b16 v[68:69], v12 offset:12288
    ds_read_b64_tr_b16 v[70:71], v12 offset:12800
    ds_read_b64_tr_b16 v[72:73], v13 offset:12288
    ds_read_b64_tr_b16 v[74:75], v13 offset:12800
    ds_read_b64_tr_b16 v[76:77], v14 offset:12288
    ds_read_b64_tr_b16 v[78:79], v14 offset:12800
    s_cmp_ge_u32 s10, 6
    s_mov_b32 s29, 0
    s_cmov_b32 s29, 20480
    s_add_u32 m0, s29, s28
    s_add_u32 s29, s29, s28
    buffer_load_dwordx4 v8, s[16:19], s48 offen lds
    s_add_u32 m0, s29, 1024
    s_nop 0
    buffer_load_dwordx4 v9, s[16:19], s48 offen lds
    s_add_u32 s48, s48, s50
    s_cmp_eq_u32 s48, s51
    s_cmov_b32 s48, 0

    v_mfma_f32_16x16x32_bf16 v[16:19], v[48:51], v[40:43], 0
    v_mfma_f32_16x16x32_bf16 v[28:31], v[48:51], v[44:47], 0
    v_mfma_f32_16x16x32_bf16 v[20:23], v[52:55], v[40:43], 0
    v_mfma_f32_16x16x32_bf16 v[32:35], v[52:55], v[44:47], 0
    v_mfma_f32_16x16x32_bf16 v[24:27], v[56:59], v[40:43], 0
    v_mfma_f32_16x16x32_bf16 v[36:39], v[56:59], v[44:47], 0
    s_waitcnt vmcnt(4) lgkmcnt(0)
    s_barrier
    ds_read_b128 v[40:43], v10 offset:8192
    ds_read_b128 v[44:47], v10 offset:10240
    ds_read_b64_tr_b16 v[48:49], v12 offset:24576
    ds_read_b64_tr_b16 v[50:51], v12 offset:25088
    ds_read_b64_tr_b16 v[52:53], v13 offset:24576
    ds_read_b64_tr_b16 v[54:55], v13 offset:25088
    ds_read_b64_tr_b16 v[56:57], v14 offset:24576
    ds_read_b64_tr_b16 v[58:59], v14 offset:25088
    s_cmp_ge_u32 s10, 6
    s_mov_b32 s29, 12288
    s_cmov_b32 s29, 0
    s_add_u32 m0, s29, s28
    s_add_u32 s29, s29, s28
    buffer_load_dwordx4 v8, s[16:19], s48 offen lds
    s_add_u32 m0, s29, 1024
    s_nop 0
    buffer_load_dwordx4 v9, s[16:19], s48 offen lds
    s_add_u32 s48, s48, s49
    s_cmp_eq_u32 s48, s51
    s_cmov_b32 s48, 0

    v_mfma_f32_16x16x32_bf16 v[16:19], v[68:71], v[60:63], v[16:19]
    v_mfma_f32_16x16x32_bf16 v[28:31], v[68:71], v[64:67], v[28:31]
    v_mfma_f32_16x16x32_bf16 v[20:23], v[72:75], v[60:63], v[20:23]
    v_mfma_f32_16x16x32_bf16 v[32:35], v[72:75], v[64:67], v[32:35]
    v_mfma_f32_16x16x32_bf16 v[24:27], v[76:79], v[60:63], v[24:27]
    v_mfma_f32_16x16x32_bf16 v[36:39], v[76:79], v[64:67], v[36:39]
    s_waitcnt vmcnt(4) lgkmcnt(0)
    s_barrier
    ds_read_b128 v[60:63], v11 offset:8192
    ds_read_b128 v[64:67], v11 offset:10240
    ds_read_b64_tr_b16 v[68:69], v12 offset:36864
    ds_read_b64_tr_b16 v[70:71], v12 offset:37376
    ds_read_b64_tr_b16 v[72:73], v13 offset:36864
    ds_read_b64_tr_b16 v[74:75], v13 offset:37376
    ds_read_b64_tr_b16 v[76:77], v14 offset:36864
    ds_read_b64_tr_b16 v[78:79], v14 offset:37376
    s_cmp_ge_u32 s10, 6
    s_mov_b32 s29, 24576
    s_cmov_b32 s29, 4096
    s_add_u32 m0, s29, s28
    s_add_u32 s29, s29, s28
    buffer_load_dwordx4 v8, s[16:19], s48 offen lds
    s_add_u32 m0, s29, 1024
    s_nop 0
    buffer_load_dwordx4 v9, s[16:19], s48 offen lds
    s_add_u32 s48, s48, s50
    s_cmp_eq_u32 s48, s51
    s_cmov_b32 s48, 0

    v_mfma_f32_16x16x32_bf16 v[16:19], v[48:51], v[40:43], v[16:19]
    v_mfma_f32_16x16x32_bf16 v[28:31], v[48:51], v[44:47], v[28:31]
    v_mfma_f32_16x16x32_bf16 v[20:23], v[52:55], v[40:43], v[20:23]
    v_mfma_f32_16x16x32_bf16 v[32:35], v[52:55], v[44:47], v[32:35]
    v_mfma_f32_16x16x32_bf16 v[24:27], v[56:59], v[40:43], v[24:27]
    v_mfma_f32_16x16x32_bf16 v[36:39], v[56:59], v[44:47], v[36:39]
    s_waitcnt vmcnt(4) lgkmcnt(0)
    s_barrier
    ds_read_b128 v[40:43], v10 offset:16384
    ds_read_b128 v[44:47], v10 offset:18432
    ds_read_b64_tr_b16 v[48:49], v12 offset:0
    ds_read_b64_tr_b16 v[50:51], v12 offset:512
    ds_read_b64_tr_b16 v[52:53], v13 offset:0
    ds_read_b64_tr_b16 v[54:55], v13 offset:512
    ds_read_b64_tr_b16 v[56:57], v14 offset:0
    ds_read_b64_tr_b16 v[58:59], v14 offset:512
    s_cmp_ge_u32 s10, 6
    s_mov_b32 s29, 36864
    s_cmov_b32 s29, 8192
    s_add_u32 m0, s29, s28
    s_add_u32 s29, s29, s28
    buffer_load_dwordx4 v8, s[16:19], s48 offen lds
    s_add_u32 m0, s29, 1024
    s_nop 0
    buffer_load_dwordx4 v9, s[16:19], s48 offen lds
    s_add_u32 s48, s48, s49
    s_cmp_eq_u32 s48, s51
    s_cmov_b32 s48, 0

    v_mfma_f32_16x16x32_bf16 v[16:19], v[68:71], v[60:63], v[16:19]
    v_mfma_f32_16x16x32_bf16 v[28:31], v[68:71], v[64:67], v[28:31]
    v_mfma_f32_16x16x32_bf16 v[20:23], v[72:75], v[60:63], v[20:23]
    v_mfma_f32_16x16x32_bf16 v[32:35], v[72:75], v[64:67], v[32:35]
    v_mfma_f32_16x16x32_bf16 v[24:27], v[76:79], v[60:63], v[24:27]
    v_mfma_f32_16x16x32_bf16 v[36:39], v[76:79], v[64:67], v[36:39]
    s_waitcnt vmcnt(4) lgkmcnt(0)
    s_barrier
    ds_read_b128 v[60:63], v11 offset:16384
    ds_read_b128 v[64:67], v11 offset:18432
    ds_read_b64_tr_b16 v[68:69], v12 offset:12288
    ds_read_b64_tr_b16 v[70:71], v12 offset:12800
    ds_read_b64_tr_b16 v[72:73], v13 offset:12288
    ds_read_b64_tr_b16 v[74:75], v13 offset:12800
    ds_read_b64_tr_b16 v[76:77], v14 offset:12288
    ds_read_b64_tr_b16 v[78:79], v14 offset:12800
    s_cmp_ge_u32 s10, 6
    s_mov_b32 s29, 0
    s_cmov_b32 s29, 12288
    s_add_u32 m0, s29, s28
    s_add_u32 s29, s29, s28
    buffer_load_dwordx4 v8, s[16:19], s48 offen lds
    s_add_u32 m0, s29, 1024
    s_nop 0
    buffer_load_dwordx4 v9, s[16:19], s48 offen lds
    s_add_u32 s48, s48, s50
    s_cmp_eq_u32 s48, s51
    s_cmov_b32 s48, 0

    v_mfma_f32_16x16x32_bf16 v[16:19], v[48:51], v[40:43], v[16:19]
    v_mfma_f32_16x16x32_bf16 v[28:31], v[48:51], v[44:47], v[28:31]
    v_mfma_f32_16x16x32_bf16 v[20:23], v[52:55], v[40:43], v[20:23]
    v_mfma_f32_16x16x32_bf16 v[32:35], v[52:55], v[44:47], v[32:35]
    v_mfma_f32_16x16x32_bf16 v[24:27], v[56:59], v[40:43], v[24:27]
    v_mfma_f32_16x16x32_bf16 v[36:39], v[56:59], v[44:47], v[36:39]
    s_waitcnt vmcnt(4) lgkmcnt(0)
    s_barrier
    ds_read_b128 v[40:43], v10 offset:0
    ds_read_b128 v[44:47], v10 offset:2048
    ds_read_b64_tr_b16 v[48:49], v12 offset:24576
    ds_read_b64_tr_b16 v[50:51], v12 offset:25088
    ds_read_b64_tr_b16 v[52:53], v13 offset:24576
    ds_read_b64_tr_b16 v[54:55], v13 offset:25088
    ds_read_b64_tr_b16 v[56:57], v14 offset:24576
    ds_read_b64_tr_b16 v[58:59], v14 offset:25088
    s_cmp_ge_u32 s10, 6
    s_mov_b32 s29, 12288
    s_cmov_b32 s29, 16384
    s_add_u32 m0, s29, s28
    s_add_u32 s29, s29, s28
    buffer_load_dwordx4 v8, s[16:19], s48 offen lds
    s_add_u32 m0, s29, 1024
    s_nop 0
    buffer_load_dwordx4 v9, s[16:19], s48 offen lds
    s_add_u32 s48, s48, s49
    s_cmp_eq_u32 s48, s51
    s_cmov_b32 s48, 0

    v_mfma_f32_16x16x32_bf16 v[16:19], v[68:71], v[60:63], v[16:19]
    v_mfma_f32_16x16x32_bf16 v[28:31], v[68:71], v[64:67], v[28:31]
    v_mfma_f32_16x16x32_bf16 v[20:23], v[72:75], v[60:63], v[20:23]
    v_mfma_f32_16x16x32_bf16 v[32:35], v[72:75], v[64:67], v[32:35]
    v_mfma_f32_16x16x32_bf16 v[24:27], v[76:79], v[60:63], v[24:27]
    v_mfma_f32_16x16x32_bf16 v[36:39], v[76:79], v[64:67], v[36:39]
    s_waitcnt vmcnt(4) lgkmcnt(0)
    s_barrier
    ds_read_b128 v[60:63], v11 offset:0
    ds_read_b128 v[64:67], v11 offset:2048
    ds_read_b64_tr_b16 v[68:69], v12 offset:36864
    ds_read_b64_tr_b16 v[70:71], v12 offset:37376
    ds_read_b64_tr_b16 v[72:73], v13 offset:36864
    ds_read_b64_tr_b16 v[74:75], v13 offset:37376
    ds_read_b64_tr_b16 v[76:77], v14 offset:36864
    ds_read_b64_tr_b16 v[78:79], v14 offset:37376
    s_cmp_ge_u32 s10, 6
    s_mov_b32 s29, 24576
    s_cmov_b32 s29, 20480
    s_add_u32 m0, s29, s28
    s_add_u32 s29, s29, s28
    buffer_load_dwordx4 v8, s[16:19], s48 offen lds
    s_add_u32 m0, s29, 1024
    s_nop 0
    buffer_load_dwordx4 v9, s[16:19], s48 offen lds
    s_add_u32 s48, s48, s50
    s_cmp_eq_u32 s48, s51
    s_cmov_b32 s48, 0

    v_mfma_f32_16x16x32_bf16 v[16:19], v[48:51], v[40:43], v[16:19]
    v_mfma_f32_16x16x32_bf16 v[28:31], v[48:51], v[44:47], v[28:31]
    v_mfma_f32_16x16x32_bf16 v[20:23], v[52:55], v[40:43], v[20:23]
    v_mfma_f32_16x16x32_bf16 v[32:35], v[52:55], v[44:47], v[32:35]
    v_mfma_f32_16x16x32_bf16 v[24:27], v[56:59], v[40:43], v[24:27]
    v_mfma_f32_16x16x32_bf16 v[36:39], v[56:59], v[44:47], v[36:39]
    s_waitcnt vmcnt(4) lgkmcnt(0)
    s_barrier
    ds_read_b128 v[40:43], v10 offset:8192
    ds_read_b128 v[44:47], v10 offset:10240
    ds_read_b64_tr_b16 v[48:49], v12 offset:0
    ds_read_b64_tr_b16 v[50:51], v12 offset:512
    ds_read_b64_tr_b16 v[52:53], v13 offset:0
    ds_read_b64_tr_b16 v[54:55], v13 offset:512
    ds_read_b64_tr_b16 v[56:57], v14 offset:0
    ds_read_b64_tr_b16 v[58:59], v14 offset:512
    s_cmp_ge_u32 s10, 6
    s_mov_b32 s29, 36864
    s_cmov_b32 s29, 0
    s_add_u32 m0, s29, s28
    s_add_u32 s29, s29, s28
    buffer_load_dwordx4 v8, s[16:19], s48 offen lds
    s_add_u32 m0, s29, 1024
    s_nop 0
    buffer_load_dwordx4 v9, s[16:19], s48 offen lds
    s_add_u32 s48, s48, s49
    s_cmp_eq_u32 s48, s51
    s_cmov_b32 s48, 0

    v_mfma_f32_16x16x32_bf16 v[16:19], v[68:71], v[60:63], v[16:19]
    v_mfma_f32_16x16x32_bf16 v[28:31], v[68:71], v[64:67], v[28:31]
    v_mfma_f32_16x16x32_bf16 v[20:23], v[72:75], v[60:63], v[20:23]
    v_mfma_f32_16x16x32_bf16 v[32:35], v[72:75], v[64:67], v[32:35]
    v_mfma_f32_16x16x32_bf16 v[24:27], v[76:79], v[60:63], v[24:27]
    v_mfma_f32_16x16x32_bf16 v[36:39], v[76:79], v[64:67], v[36:39]
    s_waitcnt vmcnt(4) lgkmcnt(0)
    s_barrier
    ds_read_b128 v[60:63], v11 offset:8192
    ds_read_b128 v[64:67], v11 offset:10240
    ds_read_b64_tr_b16 v[68:69], v12 offset:12288
    ds_read_b64_tr_b16 v[70:71], v12 offset:12800
    ds_read_b64_tr_b16 v[72:73], v13 offset:12288
    ds_read_b64_tr_b16 v[74:75], v13 offset:12800
    ds_read_b64_tr_b16 v[76:77], v14 offset:12288
    ds_read_b64_tr_b16 v[78:79], v14 offset:12800
    s_cmp_ge_u32 s10, 6
    s_mov_b32 s29, 0
    s_cmov_b32 s29, 4096
    s_add_u32 m0, s29, s28
    s_add_u32 s29, s29, s28
    buffer_load_dwordx4 v8, s[16:19], s48 offen lds
    s_add_u32 m0, s29, 1024
    s_nop 0
    buffer_load_dwordx4 v9, s[16:19], s48 offen lds
    s_add_u32 s48, s48, s50
    s_cmp_eq_u32 s48, s51
    s_cmov_b32 s48, 0

    v_mfma_f32_16x16x32_bf16 v[16:19], v[48:51], v[40:43], v[16:19]
    v_mfma_f32_16x16x32_bf16 v[28:31], v[48:51], v[44:47], v[28:31]
    v_mfma_f32_16x16x32_bf16 v[20:23], v[52:55], v[40:43], v[20:23]
    v_mfma_f32_16x16x32_bf16 v[32:35], v[52:55], v[44:47], v[32:35]
    v_mfma_f32_16x16x32_bf16 v[24:27], v[56:59], v[40:43], v[24:27]
    v_mfma_f32_16x16x32_bf16 v[36:39], v[56:59], v[44:47], v[36:39]
    s_waitcnt vmcnt(4) lgkmcnt(0)
    s_barrier
    ds_read_b128 v[40:43], v10 offset:16384
    ds_read_b128 v[44:47], v10 offset:18432
    ds_read_b64_tr_b16 v[48:49], v12 offset:24576
    ds_read_b64_tr_b16 v[50:51], v12 offset:25088
    ds_read_b64_tr_b16 v[52:53], v13 offset:24576
    ds_read_b64_tr_b16 v[54:55], v13 offset:25088
    ds_read_b64_tr_b16 v[56:57], v14 offset:24576
    ds_read_b64_tr_b16 v[58:59], v14 offset:25088
    s_cmp_ge_u32 s10, 6
    s_cbranch_scc1 QKV_skip0
    s_cmp_ge_u32 s10, 6
    s_mov_b32 s29, 12288
    s_cmov_b32 s29, 0
    s_add_u32 m0, s29, s28
    s_add_u32 s29, s29, s28
    buffer_load_dwordx4 v8, s[16:19], s48 offen lds
    s_add_u32 m0, s29, 1024
    s_nop 0
    buffer_load_dwordx4 v9, s[16:19], s48 offen lds
    s_add_u32 s48, s48, s49
    s_cmp_eq_u32 s48, s51
    s_cmov_b32 s48, 0

QKV_skip0:
    v_mfma_f32_16x16x32_bf16 v[16:19], v[68:71], v[60:63], v[16:19]
    v_mfma_f32_16x16x32_bf16 v[28:31], v[68:71], v[64:67], v[28:31]
    v_mfma_f32_16x16x32_bf16 v[20:23], v[72:75], v[60:63], v[20:23]
    v_mfma_f32_16x16x32_bf16 v[32:35], v[72:75], v[64:67], v[32:35]
    v_mfma_f32_16x16x32_bf16 v[24:27], v[76:79], v[60:63], v[24:27]
    v_mfma_f32_16x16x32_bf16 v[36:39], v[76:79], v[64:67], v[36:39]
    s_waitcnt vmcnt(2) lgkmcnt(0)
    s_barrier
    ds_read_b128 v[60:63], v11 offset:16384
    ds_read_b128 v[64:67], v11 offset:18432
    ds_read_b64_tr_b16 v[68:69], v12 offset:36864
    ds_read_b64_tr_b16 v[70:71], v12 offset:37376
    ds_read_b64_tr_b16 v[72:73], v13 offset:36864
    ds_read_b64_tr_b16 v[74:75], v13 offset:37376
    ds_read_b64_tr_b16 v[76:77], v14 offset:36864
    ds_read_b64_tr_b16 v[78:79], v14 offset:37376
    v_mfma_f32_16x16x32_bf16 v[16:19], v[48:51], v[40:43], v[16:19]
    v_mfma_f32_16x16x32_bf16 v[28:31], v[48:51], v[44:47], v[28:31]
    v_mfma_f32_16x16x32_bf16 v[20:23], v[52:55], v[40:43], v[20:23]
    v_mfma_f32_16x16x32_bf16 v[32:35], v[52:55], v[44:47], v[32:35]
    v_mfma_f32_16x16x32_bf16 v[24:27], v[56:59], v[40:43], v[24:27]
    v_mfma_f32_16x16x32_bf16 v[36:39], v[56:59], v[44:47], v[36:39]
    s_waitcnt vmcnt(0) lgkmcnt(0)
    s_barrier
    ds_read_b128 v[40:43], v10 offset:0
    ds_read_b128 v[44:47], v10 offset:2048
    ds_read_b64_tr_b16 v[48:49], v12 offset:0
    ds_read_b64_tr_b16 v[50:51], v12 offset:512
    ds_read_b64_tr_b16 v[52:53], v13 offset:0
    ds_read_b64_tr_b16 v[54:55], v13 offset:512
    ds_read_b64_tr_b16 v[56:57], v14 offset:0
    ds_read_b64_tr_b16 v[58:59], v14 offset:512
    v_mfma_f32_16x16x32_bf16 v[16:19], v[68:71], v[60:63], v[16:19]
    v_mfma_f32_16x16x32_bf16 v[28:31], v[68:71], v[64:67], v[28:31]
    v_mfma_f32_16x16x32_bf16 v[20:23], v[72:75], v[60:63], v[20:23]
    v_mfma_f32_16x16x32_bf16 v[32:35], v[72:75], v[64:67], v[32:35]
    v_mfma_f32_16x16x32_bf16 v[24:27], v[76:79], v[60:63], v[24:27]
    v_mfma_f32_16x16x32_bf16 v[36:39], v[76:79], v[64:67], v[36:39]
    s_mov_b64 exec, s[52:53]
    ds_write_b64 v80, v[90:91] offset:8
    ds_write_b64 v80, v[90:91] offset:264
    s_mov_b64 exec, s[54:55]
    ds_write_b64 v81, v[92:93] offset:8
    ds_write_b64 v81, v[92:93] offset:264
    s_mov_b64 exec, s[56:57]
    ds_write_b64 v82, v[94:95] offset:8
    ds_write_b64 v82, v[94:95] offset:264
    s_mov_b64 exec, -1
    s_waitcnt vmcnt(0) lgkmcnt(0)
    s_barrier
    ds_read_b128 v[60:63], v11 offset:0
    ds_read_b128 v[64:67], v11 offset:2048
    ds_read_b64_tr_b16 v[68:69], v12 offset:12288
    ds_read_b64_tr_b16 v[70:71], v12 offset:12800
    ds_read_b64_tr_b16 v[72:73], v13 offset:12288
    ds_read_b64_tr_b16 v[74:75], v13 offset:12800
    ds_read_b64_tr_b16 v[76:77], v14 offset:12288
    ds_read_b64_tr_b16 v[78:79], v14 offset:12800
    v_mfma_f32_16x16x32_bf16 v[16:19], v[48:51], v[40:43], v[16:19]
    v_mfma_f32_16x16x32_bf16 v[28:31], v[48:51], v[44:47], v[28:31]
    v_mfma_f32_16x16x32_bf16 v[20:23], v[52:55], v[40:43], v[20:23]
    v_mfma_f32_16x16x32_bf16 v[32:35], v[52:55], v[44:47], v[32:35]
    v_mfma_f32_16x16x32_bf16 v[24:27], v[56:59], v[40:43], v[24:27]
    v_mfma_f32_16x16x32_bf16 v[36:39], v[56:59], v[44:47], v[36:39]
    s_waitcnt lgkmcnt(0)
    v_mfma_f32_16x16x32_bf16 v[16:19], v[68:71], v[60:63], v[16:19]
    v_mfma_f32_16x16x32_bf16 v[28:31], v[68:71], v[64:67], v[28:31]
    v_mfma_f32_16x16x32_bf16 v[20:23], v[72:75], v[60:63], v[20:23]
    v_mfma_f32_16x16x32_bf16 v[32:35], v[72:75], v[64:67], v[32:35]
    v_mfma_f32_16x16x32_bf16 v[24:27], v[76:79], v[60:63], v[24:27]
    v_mfma_f32_16x16x32_bf16 v[36:39], v[76:79], v[64:67], v[36:39]
    s_nop 3
    v_mul_f32 v16, s58, v16
    v_mul_f32 v17, s58, v17
    v_mul_f32 v18, s58, v18
    v_mul_f32 v19, s58, v19
    v_cvt_pk_bf16_f32 v44, v16, v17
    v_cvt_pk_bf16_f32 v45, v18, v19
    ds_write_b64 v80, v[44:45] offset:0
    v_mul_f32 v28, s58, v28
    v_mul_f32 v29, s58, v29
    v_mul_f32 v30, s58, v30
    v_mul_f32 v31, s58, v31
    v_cvt_pk_bf16_f32 v46, v28, v29
    v_cvt_pk_bf16_f32 v47, v30, v31
    ds_write_b64 v80, v[46:47] offset:256
    v_mul_f32 v20, s59, v20
    v_mul_f32 v21, s59, v21
    v_mul_f32 v22, s59, v22
    v_mul_f32 v23, s59, v23
    v_cvt_pk_bf16_f32 v48, v20, v21
    v_cvt_pk_bf16_f32 v49, v22, v23
    ds_write_b64 v81, v[48:49] offset:0
    v_mul_f32 v32, s59, v32
    v_mul_f32 v33, s59, v33
    v_mul_f32 v34, s59, v34
    v_mul_f32 v35, s59, v35
    v_cvt_pk_bf16_f32 v50, v32, v33
    v_cvt_pk_bf16_f32 v51, v34, v35
    ds_write_b64 v81, v[50:51] offset:256
    v_mul_f32 v24, s60, v24
    v_mul_f32 v25, s60, v25
    v_mul_f32 v26, s60, v26
    v_mul_f32 v27, s60, v27
    v_cvt_pk_bf16_f32 v52, v24, v25
    v_cvt_pk_bf16_f32 v53, v26, v27
    ds_write_b64 v82, v[52:53] offset:0
    v_mul_f32 v36, s60, v36
    v_mul_f32 v37, s60, v37
    v_mul_f32 v38, s60, v38
    v_mul_f32 v39, s60, v39
    v_cvt_pk_bf16_f32 v54, v36, v37
    v_cvt_pk_bf16_f32 v55, v38, v39
    ds_write_b64 v82, v[54:55] offset:256
    s_branch QKV_end
QKV_v1:
    s_add_u32 s29, s15, 0
    s_cmp_ge_u32 s29, 448
    s_cselect_b32 s58, 1.0, 0x3e8b97f6
    s_cselect_b32 s30, 0x3f80, 0
    s_lshr_b32 s29, s29, 2
    v_add_u32 v84, s29, v4
    v_mul_u32_u24 v85, 293, v84
    v_lshrrev_b32 v85, 11, v85
    v_mul_u32_u24 v86, 7, v85
    v_sub_u32 v84, v84, v86
    v_and_b32 v86, 15, v85
    v_mov_b32 v87, 6
    v_cmp_eq_u32 vcc, 13, v86
    v_cndmask_b32 v87, v87, 4, vcc
    v_cmp_eq_u32 vcc, 11, v86
    v_cndmask_b32 v87, v87, 2, vcc
    v_cmp_eq_u32 s[52:53], v84, v87
    v_cmp_gt_u32 vcc, v84, v87
    v_subrev_u32 v86, 1, v84
    v_cndmask_b32 v84, v84, v86, vcc
    v_cndmask_b32 v84, v84, 6, s[52:53]
    v_subrev_u32 v85, s37, v85
    v_lshrrev_b32 v86, 2, v85
    v_lshl_add_u32 v85, v85, 12, v6
    v_lshl_add_u32 v85, v86, 14, v85
    v_lshrrev_b32 v86, 1, v84
    v_lshl_add_u32 v85, v86, 9, v85
    v_and_b32 v86, 1, v84
    v_lshl_add_u32 v80, v86, 3, v85
    v_mov_b32 v90, s30
    v_mov_b32 v91, 0

    s_add_u32 s29, s15, 16
    s_cmp_ge_u32 s29, 448
    s_cselect_b32 s59, 1.0, 0x3e8b97f6
    s_cselect_b32 s30, 0x3f80, 0
    s_lshr_b32 s29, s29, 2
    v_add_u32 v84, s29, v4
    v_mul_u32_u24 v85, 293, v84
    v_lshrrev_b32 v85, 11, v85
    v_mul_u32_u24 v86, 7, v85
    v_sub_u32 v84, v84, v86
    v_and_b32 v86, 15, v85
    v_mov_b32 v87, 6
    v_cmp_eq_u32 vcc, 13, v86
    v_cndmask_b32 v87, v87, 4, vcc
    v_cmp_eq_u32 vcc, 11, v86
    v_cndmask_b32 v87, v87, 2, vcc
    v_cmp_eq_u32 s[54:55], v84, v87
    v_cmp_gt_u32 vcc, v84, v87
    v_subrev_u32 v86, 1, v84
    v_cndmask_b32 v84, v84, v86, vcc
    v_cndmask_b32 v84, v84, 6, s[54:55]
    v_subrev_u32 v85, s37, v85
    v_lshrrev_b32 v86, 2, v85
    v_lshl_add_u32 v85, v85, 12, v6
    v_lshl_add_u32 v85, v86, 14, v85
    v_lshrrev_b32 v86, 1, v84
    v_lshl_add_u32 v85, v86, 9, v85
    v_and_b32 v86, 1, v84
    v_lshl_add_u32 v81, v86, 3, v85
    v_mov_b32 v92, s30
    v_mov_b32 v93, 0

    s_add_u32 s29, s15, -864
    s_sub_u32 s30, s37, 32
    v_add_u32 v84, s29, v3
    v_mul_u32_u24 v85, 293, v84
    v_lshrrev_b32 v85, 13, v85
    v_mul_u32_u24 v86, 28, v85
    v_sub_u32 v84, v84, v86
    v_subrev_u32 v85, s30, v85
    v_lshrrev_b32 v86, 2, v85
    v_lshl_add_u32 v85, v85, 12, v7
    v_lshl_add_u32 v85, v86, 14, v85
    v_and_b32 v86, 0x13, v84
    v_lshl_add_u32 v85, v86, 4, v85
    v_bfe_u32 v86, v84, 2, 1
    v_lshl_add_u32 v85, v86, 7, v85
    v_bfe_u32 v86, v84, 3, 1
    v_lshl_add_u32 v82, v86, 6, v85
    v_cmp_eq_u32 s[56:57], 24, v84

    s_waitcnt vmcnt(4) lgkmcnt(0)
    s_barrier
    ds_read_b128 v[40:43], v10 offset:0
    ds_read_b128 v[44:47], v10 offset:2048
    ds_read_b64_tr_b16 v[48:49], v12 offset:0
    ds_read_b64_tr_b16 v[50:51], v12 offset:512
    ds_read_b64_tr_b16 v[52:53], v13 offset:0
    ds_read_b64_tr_b16 v[54:55], v13 offset:512
    ds_read_b64_tr_b16 v[56:57], v14 offset:0
    ds_read_b64_tr_b16 v[58:59], v14 offset:512
    s_cmp_ge_u32 s10, 6
    s_mov_b32 s29, 36864
    s_cmov_b32 s29, 16384
    s_add_u32 m0, s29, s28
    s_add_u32 s29, s29, s28
    buffer_load_dwordx4 v8, s[16:19], s48 offen lds
    s_add_u32 m0, s29, 1024
    s_nop 0
    buffer_load_dwordx4 v9, s[16:19], s48 offen lds
    s_add_u32 s48, s48, s49
    s_cmp_eq_u32 s48, s51
    s_cmov_b32 s48, 0

    s_waitcnt vmcnt(4) lgkmcnt(0)
    s_barrier
    ds_read_b128 v[60:63], v11 offset:0
    ds_read_b128 v[64:67], v11 offset:2048
    ds_read_b64_tr_b16 v[68:69], v12 offset:12288
    ds_read_b64_tr_b16 v[70:71], v12 offset:12800
    ds_read_b64_tr_b16 v[72:73], v13 offset:12288
    ds_read_b64_tr_b16 v[74:75], v13 offset:12800
    ds_read_b64_tr_b16 v[76:77], v14 offset:12288
    ds_read_b64_tr_b16 v[78:79], v14 offset:12800
    s_cmp_ge_u32 s10, 6
    s_mov_b32 s29, 0
    s_cmov_b32 s29, 20480
    s_add_u32 m0, s29, s28
    s_add_u32 s29, s29, s28
    buffer_load_dwordx4 v8, s[16:19], s48 offen lds
    s_add_u32 m0, s29, 1024
    s_nop 0
    buffer_load_dwordx4 v9, s[16:19], s48 offen lds
    s_add_u32 s48, s48, s50
    s_cmp_eq_u32 s48, s51
    s_cmov_b32 s48, 0

    v_mfma_f32_16x16x32_bf16 v[16:19], v[48:51], v[40:43], 0
    v_mfma_f32_16x16x32_bf16 v[28:31], v[48:51], v[44:47], 0
    v_mfma_f32_16x16x32_bf16 v[20:23], v[52:55], v[40:43], 0
    v_mfma_f32_16x16x32_bf16 v[32:35], v[52:55], v[44:47], 0
    v_mfma_f32_16x16x32_bf16 v[24:27], v[40:43], v[56:59], 0
    v_mfma_f32_16x16x32_bf16 v[36:39], v[44:47], v[56:59], 0
    s_waitcnt vmcnt(4) lgkmcnt(0)
    s_barrier
    ds_read_b128 v[40:43], v10 offset:8192
    ds_read_b128 v[44:47], v10 offset:10240
    ds_read_b64_tr_b16 v[48:49], v12 offset:24576
    ds_read_b64_tr_b16 v[50:51], v12 offset:25088
    ds_read_b64_tr_b16 v[52:53], v13 offset:24576
    ds_read_b64_tr_b16 v[54:55], v13 offset:25088
    ds_read_b64_tr_b16 v[56:57], v14 offset:24576
    ds_read_b64_tr_b16 v[58:59], v14 offset:25088
    s_cmp_ge_u32 s10, 6
    s_mov_b32 s29, 12288
    s_cmov_b32 s29, 0
    s_add_u32 m0, s29, s28
    s_add_u32 s29, s29, s28
    buffer_load_dwordx4 v8, s[16:19], s48 offen lds
    s_add_u32 m0, s29, 1024
    s_nop 0
    buffer_load_dwordx4 v9, s[16:19], s48 offen lds
    s_add_u32 s48, s48, s49
    s_cmp_eq_u32 s48, s51
    s_cmov_b32 s48, 0

    v_mfma_f32_16x16x32_bf16 v[16:19], v[68:71], v[60:63], v[16:19]
    v_mfma_f32_16x16x32_bf16 v[28:31], v[68:71], v[64:67], v[28:31]
    v_mfma_f32_16x16x32_bf16 v[20:23], v[72:75], v[60:63], v[20:23]
    v_mfma_f32_16x16x32_bf16 v[32:35], v[72:75], v[64:67], v[32:35]
    v_mfma_f32_16x16x32_bf16 v[24:27], v[60:63], v[76:79], v[24:27]
    v_mfma_f32_16x16x32_bf16 v[36:39], v[64:67], v[76:79], v[36:39]
    s_waitcnt vmcnt(4) lgkmcnt(0)
    s_barrier
    ds_read_b128 v[60:63], v11 offset:8192
    ds_read_b128 v[64:67], v11 offset:10240
    ds_read_b64_tr_b16 v[68:69], v12 offset:36864
    ds_read_b64_tr_b16 v[70:71], v12 offset:37376
    ds_read_b64_tr_b16 v[72:73], v13 offset:36864
    ds_read_b64_tr_b16 v[74:75], v13 offset:37376
    ds_read_b64_tr_b16 v[76:77], v14 offset:36864
    ds_read_b64_tr_b16 v[78:79], v14 offset:37376
    s_cmp_ge_u32 s10, 6
    s_mov_b32 s29, 24576
    s_cmov_b32 s29, 4096
    s_add_u32 m0, s29, s28
    s_add_u32 s29, s29, s28
    buffer_load_dwordx4 v8, s[16:19], s48 offen lds
    s_add_u32 m0, s29, 1024
    s_nop 0
    buffer_load_dwordx4 v9, s[16:19], s48 offen lds
    s_add_u32 s48, s48, s50
    s_cmp_eq_u32 s48, s51
    s_cmov_b32 s48, 0

    v_mfma_f32_16x16x32_bf16 v[16:19], v[48:51], v[40:43], v[16:19]
    v_mfma_f32_16x16x32_bf16 v[28:31], v[48:51], v[44:47], v[28:31]
    v_mfma_f32_16x16x32_bf16 v[20:23], v[52:55], v[40:43], v[20:23]
    v_mfma_f32_16x16x32_bf16 v[32:35], v[52:55], v[44:47], v[32:35]
    v_mfma_f32_16x16x32_bf16 v[24:27], v[40:43], v[56:59], v[24:27]
    v_mfma_f32_16x16x32_bf16 v[36:39], v[44:47], v[56:59], v[36:39]
    s_waitcnt vmcnt(4) lgkmcnt(0)
    s_barrier
    ds_read_b128 v[40:43], v10 offset:16384
    ds_read_b128 v[44:47], v10 offset:18432
    ds_read_b64_tr_b16 v[48:49], v12 offset:0
    ds_read_b64_tr_b16 v[50:51], v12 offset:512
    ds_read_b64_tr_b16 v[52:53], v13 offset:0
    ds_read_b64_tr_b16 v[54:55], v13 offset:512
    ds_read_b64_tr_b16 v[56:57], v14 offset:0
    ds_read_b64_tr_b16 v[58:59], v14 offset:512
    s_cmp_ge_u32 s10, 6
    s_mov_b32 s29, 36864
    s_cmov_b32 s29, 8192
    s_add_u32 m0, s29, s28
    s_add_u32 s29, s29, s28
    buffer_load_dwordx4 v8, s[16:19], s48 offen lds
    s_add_u32 m0, s29, 1024
    s_nop 0
    buffer_load_dwordx4 v9, s[16:19], s48 offen lds
    s_add_u32 s48, s48, s49
    s_cmp_eq_u32 s48, s51
    s_cmov_b32 s48, 0

    v_mfma_f32_16x16x32_bf16 v[16:19], v[68:71], v[60:63], v[16:19]
    v_mfma_f32_16x16x32_bf16 v[28:31], v[68:71], v[64:67], v[28:31]
    v_mfma_f32_16x16x32_bf16 v[20:23], v[72:75], v[60:63], v[20:23]
    v_mfma_f32_16x16x32_bf16 v[32:35], v[72:75], v[64:67], v[32:35]
    v_mfma_f32_16x16x32_bf16 v[24:27], v[60:63], v[76:79], v[24:27]
    v_mfma_f32_16x16x32_bf16 v[36:39], v[64:67], v[76:79], v[36:39]
    s_waitcnt vmcnt(4) lgkmcnt(0)
    s_barrier
    ds_read_b128 v[60:63], v11 offset:16384
    ds_read_b128 v[64:67], v11 offset:18432
    ds_read_b64_tr_b16 v[68:69], v12 offset:12288
    ds_read_b64_tr_b16 v[70:71], v12 offset:12800
    ds_read_b64_tr_b16 v[72:73], v13 offset:12288
    ds_read_b64_tr_b16 v[74:75], v13 offset:12800
    ds_read_b64_tr_b16 v[76:77], v14 offset:12288
    ds_read_b64_tr_b16 v[78:79], v14 offset:12800
    s_cmp_ge_u32 s10, 6
    s_mov_b32 s29, 0
    s_cmov_b32 s29, 12288
    s_add_u32 m0, s29, s28
    s_add_u32 s29, s29, s28
    buffer_load_dwordx4 v8, s[16:19], s48 offen lds
    s_add_u32 m0, s29, 1024
    s_nop 0
    buffer_load_dwordx4 v9, s[16:19], s48 offen lds
    s_add_u32 s48, s48, s50
    s_cmp_eq_u32 s48, s51
    s_cmov_b32 s48, 0

    v_mfma_f32_16x16x32_bf16 v[16:19], v[48:51], v[40:43], v[16:19]
    v_mfma_f32_16x16x32_bf16 v[28:31], v[48:51], v[44:47], v[28:31]
    v_mfma_f32_16x16x32_bf16 v[20:23], v[52:55], v[40:43], v[20:23]
    v_mfma_f32_16x16x32_bf16 v[32:35], v[52:55], v[44:47], v[32:35]
    v_mfma_f32_16x16x32_bf16 v[24:27], v[40:43], v[56:59], v[24:27]
    v_mfma_f32_16x16x32_bf16 v[36:39], v[44:47], v[56:59], v[36:39]
    s_waitcnt vmcnt(4) lgkmcnt(0)
    s_barrier
    ds_read_b128 v[40:43], v10 offset:0
    ds_read_b128 v[44:47], v10 offset:2048
    ds_read_b64_tr_b16 v[48:49], v12 offset:24576
    ds_read_b64_tr_b16 v[50:51], v12 offset:25088
    ds_read_b64_tr_b16 v[52:53], v13 offset:24576
    ds_read_b64_tr_b16 v[54:55], v13 offset:25088
    ds_read_b64_tr_b16 v[56:57], v14 offset:24576
    ds_read_b64_tr_b16 v[58:59], v14 offset:25088
    s_cmp_ge_u32 s10, 6
    s_mov_b32 s29, 12288
    s_cmov_b32 s29, 16384
    s_add_u32 m0, s29, s28
    s_add_u32 s29, s29, s28
    buffer_load_dwordx4 v8, s[16:19], s48 offen lds
    s_add_u32 m0, s29, 1024
    s_nop 0
    buffer_load_dwordx4 v9, s[16:19], s48 offen lds
    s_add_u32 s48, s48, s49
    s_cmp_eq_u32 s48, s51
    s_cmov_b32 s48, 0

    v_mfma_f32_16x16x32_bf16 v[16:19], v[68:71], v[60:63], v[16:19]
    v_mfma_f32_16x16x32_bf16 v[28:31], v[68:71], v[64:67], v[28:31]
    v_mfma_f32_16x16x32_bf16 v[20:23], v[72:75], v[60:63], v[20:23]
    v_mfma_f32_16x16x32_bf16 v[32:35], v[72:75], v[64:67], v[32:35]
    v_mfma_f32_16x16x32_bf16 v[24:27], v[60:63], v[76:79], v[24:27]
    v_mfma_f32_16x16x32_bf16 v[36:39], v[64:67], v[76:79], v[36:39]
    s_waitcnt vmcnt(4) lgkmcnt(0)
    s_barrier
    ds_read_b128 v[60:63], v11 offset:0
    ds_read_b128 v[64:67], v11 offset:2048
    ds_read_b64_tr_b16 v[68:69], v12 offset:36864
    ds_read_b64_tr_b16 v[70:71], v12 offset:37376
    ds_read_b64_tr_b16 v[72:73], v13 offset:36864
    ds_read_b64_tr_b16 v[74:75], v13 offset:37376
    ds_read_b64_tr_b16 v[76:77], v14 offset:36864
    ds_read_b64_tr_b16 v[78:79], v14 offset:37376
    s_cmp_ge_u32 s10, 6
    s_mov_b32 s29, 24576
    s_cmov_b32 s29, 20480
    s_add_u32 m0, s29, s28
    s_add_u32 s29, s29, s28
    buffer_load_dwordx4 v8, s[16:19], s48 offen lds
    s_add_u32 m0, s29, 1024
    s_nop 0
    buffer_load_dwordx4 v9, s[16:19], s48 offen lds
    s_add_u32 s48, s48, s50
    s_cmp_eq_u32 s48, s51
    s_cmov_b32 s48, 0

    v_mfma_f32_16x16x32_bf16 v[16:19], v[48:51], v[40:43], v[16:19]
    v_mfma_f32_16x16x32_bf16 v[28:31], v[48:51], v[44:47], v[28:31]
    v_mfma_f32_16x16x32_bf16 v[20:23], v[52:55], v[40:43], v[20:23]
    v_mfma_f32_16x16x32_bf16 v[32:35], v[52:55], v[44:47], v[32:35]
    v_mfma_f32_16x16x32_bf16 v[24:27], v[40:43], v[56:59], v[24:27]
    v_mfma_f32_16x16x32_bf16 v[36:39], v[44:47], v[56:59], v[36:39]
    s_waitcnt vmcnt(4) lgkmcnt(0)
    s_barrier
    ds_read_b128 v[40:43], v10 offset:8192
    ds_read_b128 v[44:47], v10 offset:10240
    ds_read_b64_tr_b16 v[48:49], v12 offset:0
    ds_read_b64_tr_b16 v[50:51], v12 offset:512
    ds_read_b64_tr_b16 v[52:53], v13 offset:0
    ds_read_b64_tr_b16 v[54:55], v13 offset:512
    ds_read_b64_tr_b16 v[56:57], v14 offset:0
    ds_read_b64_tr_b16 v[58:59], v14 offset:512
    s_cmp_ge_u32 s10, 6
    s_mov_b32 s29, 36864
    s_cmov_b32 s29, 0
    s_add_u32 m0, s29, s28
    s_add_u32 s29, s29, s28
    buffer_load_dwordx4 v8, s[16:19], s48 offen lds
    s_add_u32 m0, s29, 1024
    s_nop 0
    buffer_load_dwordx4 v9, s[16:19], s48 offen lds
    s_add_u32 s48, s48, s49
    s_cmp_eq_u32 s48, s51
    s_cmov_b32 s48, 0

    v_mfma_f32_16x16x32_bf16 v[16:19], v[68:71], v[60:63], v[16:19]
    v_mfma_f32_16x16x32_bf16 v[28:31], v[68:71], v[64:67], v[28:31]
    v_mfma_f32_16x16x32_bf16 v[20:23], v[72:75], v[60:63], v[20:23]
    v_mfma_f32_16x16x32_bf16 v[32:35], v[72:75], v[64:67], v[32:35]
    v_mfma_f32_16x16x32_bf16 v[24:27], v[60:63], v[76:79], v[24:27]
    v_mfma_f32_16x16x32_bf16 v[36:39], v[64:67], v[76:79], v[36:39]
    s_waitcnt vmcnt(4) lgkmcnt(0)
    s_barrier
    ds_read_b128 v[60:63], v11 offset:8192
    ds_read_b128 v[64:67], v11 offset:10240
    ds_read_b64_tr_b16 v[68:69], v12 offset:12288
    ds_read_b64_tr_b16 v[70:71], v12 offset:12800
    ds_read_b64_tr_b16 v[72:73], v13 offset:12288
    ds_read_b64_tr_b16 v[74:75], v13 offset:12800
    ds_read_b64_tr_b16 v[76:77], v14 offset:12288
    ds_read_b64_tr_b16 v[78:79], v14 offset:12800
    s_cmp_ge_u32 s10, 6
    s_mov_b32 s29, 0
    s_cmov_b32 s29, 4096
    s_add_u32 m0, s29, s28
    s_add_u32 s29, s29, s28
    buffer_load_dwordx4 v8, s[16:19], s48 offen lds
    s_add_u32 m0, s29, 1024
    s_nop 0
    buffer_load_dwordx4 v9, s[16:19], s48 offen lds
    s_add_u32 s48, s48, s50
    s_cmp_eq_u32 s48, s51
    s_cmov_b32 s48, 0

    v_mfma_f32_16x16x32_bf16 v[16:19], v[48:51], v[40:43], v[16:19]
    v_mfma_f32_16x16x32_bf16 v[28:31], v[48:51], v[44:47], v[28:31]
    v_mfma_f32_16x16x32_bf16 v[20:23], v[52:55], v[40:43], v[20:23]
    v_mfma_f32_16x16x32_bf16 v[32:35], v[52:55], v[44:47], v[32:35]
    v_mfma_f32_16x16x32_bf16 v[24:27], v[40:43], v[56:59], v[24:27]
    v_mfma_f32_16x16x32_bf16 v[36:39], v[44:47], v[56:59], v[36:39]
    s_waitcnt vmcnt(4) lgkmcnt(0)
    s_barrier
    ds_read_b128 v[40:43], v10 offset:16384
    ds_read_b128 v[44:47], v10 offset:18432
    ds_read_b64_tr_b16 v[48:49], v12 offset:24576
    ds_read_b64_tr_b16 v[50:51], v12 offset:25088
    ds_read_b64_tr_b16 v[52:53], v13 offset:24576
    ds_read_b64_tr_b16 v[54:55], v13 offset:25088
    ds_read_b64_tr_b16 v[56:57], v14 offset:24576
    ds_read_b64_tr_b16 v[58:59], v14 offset:25088
    s_cmp_ge_u32 s10, 6
    s_cbranch_scc1 QKV_skip1
    s_cmp_ge_u32 s10, 6
    s_mov_b32 s29, 12288
    s_cmov_b32 s29, 0
    s_add_u32 m0, s29, s28
    s_add_u32 s29, s29, s28
    buffer_load_dwordx4 v8, s[16:19], s48 offen lds
    s_add_u32 m0, s29, 1024
    s_nop 0
    buffer_load_dwordx4 v9, s[16:19], s48 offen lds
    s_add_u32 s48, s48, s49
    s_cmp_eq_u32 s48, s51
    s_cmov_b32 s48, 0

QKV_skip1:
    v_mfma_f32_16x16x32_bf16 v[16:19], v[68:71], v[60:63], v[16:19]
    v_mfma_f32_16x16x32_bf16 v[28:31], v[68:71], v[64:67], v[28:31]
    v_mfma_f32_16x16x32_bf16 v[20:23], v[72:75], v[60:63], v[20:23]
    v_mfma_f32_16x16x32_bf16 v[32:35], v[72:75], v[64:67], v[32:35]
    v_mfma_f32_16x16x32_bf16 v[24:27], v[60:63], v[76:79], v[24:27]
    v_mfma_f32_16x16x32_bf16 v[36:39], v[64:67], v[76:79], v[36:39]
    s_waitcnt vmcnt(2) lgkmcnt(0)
    s_barrier
    ds_read_b128 v[60:63], v11 offset:16384
    ds_read_b128 v[64:67], v11 offset:18432
    ds_read_b64_tr_b16 v[68:69], v12 offset:36864
    ds_read_b64_tr_b16 v[70:71], v12 offset:37376
    ds_read_b64_tr_b16 v[72:73], v13 offset:36864
    ds_read_b64_tr_b16 v[74:75], v13 offset:37376
    ds_read_b64_tr_b16 v[76:77], v14 offset:36864
    ds_read_b64_tr_b16 v[78:79], v14 offset:37376
    v_mfma_f32_16x16x32_bf16 v[16:19], v[48:51], v[40:43], v[16:19]
    v_mfma_f32_16x16x32_bf16 v[28:31], v[48:51], v[44:47], v[28:31]
    v_mfma_f32_16x16x32_bf16 v[20:23], v[52:55], v[40:43], v[20:23]
    v_mfma_f32_16x16x32_bf16 v[32:35], v[52:55], v[44:47], v[32:35]
    v_mfma_f32_16x16x32_bf16 v[24:27], v[40:43], v[56:59], v[24:27]
    v_mfma_f32_16x16x32_bf16 v[36:39], v[44:47], v[56:59], v[36:39]
    s_waitcnt vmcnt(0) lgkmcnt(0)
    s_barrier
    ds_read_b128 v[40:43], v10 offset:0
    ds_read_b128 v[44:47], v10 offset:2048
    ds_read_b64_tr_b16 v[48:49], v12 offset:0
    ds_read_b64_tr_b16 v[50:51], v12 offset:512
    ds_read_b64_tr_b16 v[52:53], v13 offset:0
    ds_read_b64_tr_b16 v[54:55], v13 offset:512
    ds_read_b64_tr_b16 v[56:57], v14 offset:0
    ds_read_b64_tr_b16 v[58:59], v14 offset:512
    v_mfma_f32_16x16x32_bf16 v[16:19], v[68:71], v[60:63], v[16:19]
    v_mfma_f32_16x16x32_bf16 v[28:31], v[68:71], v[64:67], v[28:31]
    v_mfma_f32_16x16x32_bf16 v[20:23], v[72:75], v[60:63], v[20:23]
    v_mfma_f32_16x16x32_bf16 v[32:35], v[72:75], v[64:67], v[32:35]
    v_mfma_f32_16x16x32_bf16 v[24:27], v[60:63], v[76:79], v[24:27]
    v_mfma_f32_16x16x32_bf16 v[36:39], v[64:67], v[76:79], v[36:39]
    s_mov_b64 exec, s[52:53]
    ds_write_b64 v80, v[90:91] offset:8
    ds_write_b64 v80, v[90:91] offset:264
    s_mov_b64 exec, s[54:55]
    ds_write_b64 v81, v[92:93] offset:8
    ds_write_b64 v81, v[92:93] offset:264
    s_mov_b64 exec, s[56:57]
    ds_write_b64 v82, v[96:97] offset:128
    ds_write_b64 v82, v[96:97] offset:1152
    s_mov_b64 exec, -1
    s_waitcnt vmcnt(0) lgkmcnt(0)
    s_barrier
    ds_read_b128 v[60:63], v11 offset:0
    ds_read_b128 v[64:67], v11 offset:2048
    ds_read_b64_tr_b16 v[68:69], v12 offset:12288
    ds_read_b64_tr_b16 v[70:71], v12 offset:12800
    ds_read_b64_tr_b16 v[72:73], v13 offset:12288
    ds_read_b64_tr_b16 v[74:75], v13 offset:12800
    ds_read_b64_tr_b16 v[76:77], v14 offset:12288
    ds_read_b64_tr_b16 v[78:79], v14 offset:12800
    v_mfma_f32_16x16x32_bf16 v[16:19], v[48:51], v[40:43], v[16:19]
    v_mfma_f32_16x16x32_bf16 v[28:31], v[48:51], v[44:47], v[28:31]
    v_mfma_f32_16x16x32_bf16 v[20:23], v[52:55], v[40:43], v[20:23]
    v_mfma_f32_16x16x32_bf16 v[32:35], v[52:55], v[44:47], v[32:35]
    v_mfma_f32_16x16x32_bf16 v[24:27], v[40:43], v[56:59], v[24:27]
    v_mfma_f32_16x16x32_bf16 v[36:39], v[44:47], v[56:59], v[36:39]
    s_waitcnt lgkmcnt(0)
    v_mfma_f32_16x16x32_bf16 v[16:19], v[68:71], v[60:63], v[16:19]
    v_mfma_f32_16x16x32_bf16 v[28:31], v[68:71], v[64:67], v[28:31]
    v_mfma_f32_16x16x32_bf16 v[20:23], v[72:75], v[60:63], v[20:23]
    v_mfma_f32_16x16x32_bf16 v[32:35], v[72:75], v[64:67], v[32:35]
    v_mfma_f32_16x16x32_bf16 v[24:27], v[60:63], v[76:79], v[24:27]
    v_mfma_f32_16x16x32_bf16 v[36:39], v[64:67], v[76:79], v[36:39]
    s_nop 3
    v_mul_f32 v16, s58, v16
    v_mul_f32 v17, s58, v17
    v_mul_f32 v18, s58, v18
    v_mul_f32 v19, s58, v19
    v_cvt_pk_bf16_f32 v44, v16, v17
    v_cvt_pk_bf16_f32 v45, v18, v19
    ds_write_b64 v80, v[44:45] offset:0
    v_mul_f32 v28, s58, v28
    v_mul_f32 v29, s58, v29
    v_mul_f32 v30, s58, v30
    v_mul_f32 v31, s58, v31
    v_cvt_pk_bf16_f32 v46, v28, v29
    v_cvt_pk_bf16_f32 v47, v30, v31
    ds_write_b64 v80, v[46:47] offset:256
    v_mul_f32 v20, s59, v20
    v_mul_f32 v21, s59, v21
    v_mul_f32 v22, s59, v22
    v_mul_f32 v23, s59, v23
    v_cvt_pk_bf16_f32 v48, v20, v21
    v_cvt_pk_bf16_f32 v49, v22, v23
    ds_write_b64 v81, v[48:49] offset:0
    v_mul_f32 v32, s59, v32
    v_mul_f32 v33, s59, v33
    v_mul_f32 v34, s59, v34
    v_mul_f32 v35, s59, v35
    v_cvt_pk_bf16_f32 v50, v32, v33
    v_cvt_pk_bf16_f32 v51, v34, v35
    ds_write_b64 v81, v[50:51] offset:256
    v_cvt_pk_bf16_f32 v52, v24, v25
    v_cvt_pk_bf16_f32 v53, v26, v27
    ds_write_b64 v82, v[52:53] offset:0
    v_cvt_pk_bf16_f32 v54, v36, v37
    v_cvt_pk_bf16_f32 v55, v38, v39
    ds_write_b64 v82, v[54:55] offset:1024
    s_branch QKV_end
QKV_v3:
    s_add_u32 s29, s15, -896
    s_sub_u32 s30, s37, 32
    v_add_u32 v84, s29, v3
    v_mul_u32_u24 v85, 293, v84
    v_lshrrev_b32 v85, 13, v85
    v_mul_u32_u24 v86, 28, v85
    v_sub_u32 v84, v84, v86
    v_subrev_u32 v85, s30, v85
    v_lshrrev_b32 v86, 2, v85
    v_lshl_add_u32 v85, v85, 12, v7
    v_lshl_add_u32 v85, v86, 14, v85
    v_and_b32 v86, 0x13, v84
    v_lshl_add_u32 v85, v86, 4, v85
    v_bfe_u32 v86, v84, 2, 1
    v_lshl_add_u32 v85, v86, 7, v85
    v_bfe_u32 v86, v84, 3, 1
    v_lshl_add_u32 v80, v86, 6, v85
    v_cmp_eq_u32 s[52:53], 24, v84

    s_add_u32 s29, s15, -880
    s_sub_u32 s30, s37, 32
    v_add_u32 v84, s29, v3
    v_mul_u32_u24 v85, 293, v84
    v_lshrrev_b32 v85, 13, v85
    v_mul_u32_u24 v86, 28, v85
    v_sub_u32 v84, v84, v86
    v_subrev_u32 v85, s30, v85
    v_lshrrev_b32 v86, 2, v85
    v_lshl_add_u32 v85, v85, 12, v7
    v_lshl_add_u32 v85, v86, 14, v85
    v_and_b32 v86, 0x13, v84
    v_lshl_add_u32 v85, v86, 4, v85
    v_bfe_u32 v86, v84, 2, 1
    v_lshl_add_u32 v85, v86, 7, v85
    v_bfe_u32 v86, v84, 3, 1
    v_lshl_add_u32 v81, v86, 6, v85
    v_cmp_eq_u32 s[54:55], 24, v84

    s_add_u32 s29, s15, -864
    s_sub_u32 s30, s37, 32
    v_add_u32 v84, s29, v3
    v_mul_u32_u24 v85, 293, v84
    v_lshrrev_b32 v85, 13, v85
    v_mul_u32_u24 v86, 28, v85
    v_sub_u32 v84, v84, v86
    v_subrev_u32 v85, s30, v85
    v_lshrrev_b32 v86, 2, v85
    v_lshl_add_u32 v85, v85, 12, v7
    v_lshl_add_u32 v85, v86, 14, v85
    v_and_b32 v86, 0x13, v84
    v_lshl_add_u32 v85, v86, 4, v85
    v_bfe_u32 v86, v84, 2, 1
    v_lshl_add_u32 v85, v86, 7, v85
    v_bfe_u32 v86, v84, 3, 1
    v_lshl_add_u32 v82, v86, 6, v85
    v_cmp_eq_u32 s[56:57], 24, v84

    s_waitcnt vmcnt(4) lgkmcnt(0)
    s_barrier
    ds_read_b128 v[40:43], v10 offset:0
    ds_read_b128 v[44:47], v10 offset:2048
    ds_read_b64_tr_b16 v[48:49], v12 offset:0
    ds_read_b64_tr_b16 v[50:51], v12 offset:512
    ds_read_b64_tr_b16 v[52:53], v13 offset:0
    ds_read_b64_tr_b16 v[54:55], v13 offset:512
    ds_read_b64_tr_b16 v[56:57], v14 offset:0
    ds_read_b64_tr_b16 v[58:59], v14 offset:512
    s_cmp_ge_u32 s10, 6
    s_mov_b32 s29, 36864
    s_cmov_b32 s29, 16384
    s_add_u32 m0, s29, s28
    s_add_u32 s29, s29, s28
    buffer_load_dwordx4 v8, s[16:19], s48 offen lds
    s_add_u32 m0, s29, 1024
    s_nop 0
    buffer_load_dwordx4 v9, s[16:19], s48 offen lds
    s_add_u32 s48, s48, s49
    s_cmp_eq_u32 s48, s51
    s_cmov_b32 s48, 0

    s_waitcnt vmcnt(4) lgkmcnt(0)
    s_barrier
    ds_read_b128 v[60:63], v11 offset:0
    ds_read_b128 v[64:67], v11 offset:2048
    ds_read_b64_tr_b16 v[68:69], v12 offset:12288
    ds_read_b64_tr_b16 v[70:71], v12 offset:12800
    ds_read_b64_tr_b16 v[72:73], v13 offset:12288
    ds_read_b64_tr_b16 v[74:75], v13 offset:12800
    ds_read_b64_tr_b16 v[76:77], v14 offset:12288
    ds_read_b64_tr_b16 v[78:79], v14 offset:12800
    s_cmp_ge_u32 s10, 6
    s_mov_b32 s29, 0
    s_cmov_b32 s29, 20480
    s_add_u32 m0, s29, s28
    s_add_u32 s29, s29, s28
    buffer_load_dwordx4 v8, s[16:19], s48 offen lds
    s_add_u32 m0, s29, 1024
    s_nop 0
    buffer_load_dwordx4 v9, s[16:19], s48 offen lds
    s_add_u32 s48, s48, s50
    s_cmp_eq_u32 s48, s51
    s_cmov_b32 s48, 0

    v_mfma_f32_16x16x32_bf16 v[16:19], v[40:43], v[48:51], 0
    v_mfma_f32_16x16x32_bf16 v[28:31], v[44:47], v[48:51], 0
    v_mfma_f32_16x16x32_bf16 v[20:23], v[40:43], v[52:55], 0
    v_mfma_f32_16x16x32_bf16 v[32:35], v[44:47], v[52:55], 0
    v_mfma_f32_16x16x32_bf16 v[24:27], v[40:43], v[56:59], 0
    v_mfma_f32_16x16x32_bf16 v[36:39], v[44:47], v[56:59], 0
    s_waitcnt vmcnt(4) lgkmcnt(0)
    s_barrier
    ds_read_b128 v[40:43], v10 offset:8192
    ds_read_b128 v[44:47], v10 offset:10240
    ds_read_b64_tr_b16 v[48:49], v12 offset:24576
    ds_read_b64_tr_b16 v[50:51], v12 offset:25088
    ds_read_b64_tr_b16 v[52:53], v13 offset:24576
    ds_read_b64_tr_b16 v[54:55], v13 offset:25088
    ds_read_b64_tr_b16 v[56:57], v14 offset:24576
    ds_read_b64_tr_b16 v[58:59], v14 offset:25088
    s_cmp_ge_u32 s10, 6
    s_mov_b32 s29, 12288
    s_cmov_b32 s29, 0
    s_add_u32 m0, s29, s28
    s_add_u32 s29, s29, s28
    buffer_load_dwordx4 v8, s[16:19], s48 offen lds
    s_add_u32 m0, s29, 1024
    s_nop 0
    buffer_load_dwordx4 v9, s[16:19], s48 offen lds
    s_add_u32 s48, s48, s49
    s_cmp_eq_u32 s48, s51
    s_cmov_b32 s48, 0

    v_mfma_f32_16x16x32_bf16 v[16:19], v[60:63], v[68:71], v[16:19]
    v_mfma_f32_16x16x32_bf16 v[28:31], v[64:67], v[68:71], v[28:31]
    v_mfma_f32_16x16x32_bf16 v[20:23], v[60:63], v[72:75], v[20:23]
    v_mfma_f32_16x16x32_bf16 v[32:35], v[64:67], v[72:75], v[32:35]
    v_mfma_f32_16x16x32_bf16 v[24:27], v[60:63], v[76:79], v[24:27]
    v_mfma_f32_16x16x32_bf16 v[36:39], v[64:67], v[76:79], v[36:39]
    s_waitcnt vmcnt(4) lgkmcnt(0)
    s_barrier
    ds_read_b128 v[60:63], v11 offset:8192
    ds_read_b128 v[64:67], v11 offset:10240
    ds_read_b64_tr_b16 v[68:69], v12 offset:36864
    ds_read_b64_tr_b16 v[70:71], v12 offset:37376
    ds_read_b64_tr_b16 v[72:73], v13 offset:36864
    ds_read_b64_tr_b16 v[74:75], v13 offset:37376
    ds_read_b64_tr_b16 v[76:77], v14 offset:36864
    ds_read_b64_tr_b16 v[78:79], v14 offset:37376
    s_cmp_ge_u32 s10, 6
    s_mov_b32 s29, 24576
    s_cmov_b32 s29, 4096
    s_add_u32 m0, s29, s28
    s_add_u32 s29, s29, s28
    buffer_load_dwordx4 v8, s[16:19], s48 offen lds
    s_add_u32 m0, s29, 1024
    s_nop 0
    buffer_load_dwordx4 v9, s[16:19], s48 offen lds
    s_add_u32 s48, s48, s50
    s_cmp_eq_u32 s48, s51
    s_cmov_b32 s48, 0

    v_mfma_f32_16x16x32_bf16 v[16:19], v[40:43], v[48:51], v[16:19]
    v_mfma_f32_16x16x32_bf16 v[28:31], v[44:47], v[48:51], v[28:31]
    v_mfma_f32_16x16x32_bf16 v[20:23], v[40:43], v[52:55], v[20:23]
    v_mfma_f32_16x16x32_bf16 v[32:35], v[44:47], v[52:55], v[32:35]
    v_mfma_f32_16x16x32_bf16 v[24:27], v[40:43], v[56:59], v[24:27]
    v_mfma_f32_16x16x32_bf16 v[36:39], v[44:47], v[56:59], v[36:39]
    s_waitcnt vmcnt(4) lgkmcnt(0)
    s_barrier
    ds_read_b128 v[40:43], v10 offset:16384
    ds_read_b128 v[44:47], v10 offset:18432
    ds_read_b64_tr_b16 v[48:49], v12 offset:0
    ds_read_b64_tr_b16 v[50:51], v12 offset:512
    ds_read_b64_tr_b16 v[52:53], v13 offset:0
    ds_read_b64_tr_b16 v[54:55], v13 offset:512
    ds_read_b64_tr_b16 v[56:57], v14 offset:0
    ds_read_b64_tr_b16 v[58:59], v14 offset:512
    s_cmp_ge_u32 s10, 6
    s_mov_b32 s29, 36864
    s_cmov_b32 s29, 8192
    s_add_u32 m0, s29, s28
    s_add_u32 s29, s29, s28
    buffer_load_dwordx4 v8, s[16:19], s48 offen lds
    s_add_u32 m0, s29, 1024
    s_nop 0
    buffer_load_dwordx4 v9, s[16:19], s48 offen lds
    s_add_u32 s48, s48, s49
    s_cmp_eq_u32 s48, s51
    s_cmov_b32 s48, 0

    v_mfma_f32_16x16x32_bf16 v[16:19], v[60:63], v[68:71], v[16:19]
    v_mfma_f32_16x16x32_bf16 v[28:31], v[64:67], v[68:71], v[28:31]
    v_mfma_f32_16x16x32_bf16 v[20:23], v[60:63], v[72:75], v[20:23]
    v_mfma_f32_16x16x32_bf16 v[32:35], v[64:67], v[72:75], v[32:35]
    v_mfma_f32_16x16x32_bf16 v[24:27], v[60:63], v[76:79], v[24:27]
    v_mfma_f32_16x16x32_bf16 v[36:39], v[64:67], v[76:79], v[36:39]
    s_waitcnt vmcnt(4) lgkmcnt(0)
    s_barrier
    ds_read_b128 v[60:63], v11 offset:16384
    ds_read_b128 v[64:67], v11 offset:18432
    ds_read_b64_tr_b16 v[68:69], v12 offset:12288
    ds_read_b64_tr_b16 v[70:71], v12 offset:12800
    ds_read_b64_tr_b16 v[72:73], v13 offset:12288
    ds_read_b64_tr_b16 v[74:75], v13 offset:12800
    ds_read_b64_tr_b16 v[76:77], v14 offset:12288
    ds_read_b64_tr_b16 v[78:79], v14 offset:12800
    s_cmp_ge_u32 s10, 6
    s_mov_b32 s29, 0
    s_cmov_b32 s29, 12288
    s_add_u32 m0, s29, s28
    s_add_u32 s29, s29, s28
    buffer_load_dwordx4 v8, s[16:19], s48 offen lds
    s_add_u32 m0, s29, 1024
    s_nop 0
    buffer_load_dwordx4 v9, s[16:19], s48 offen lds
    s_add_u32 s48, s48, s50
    s_cmp_eq_u32 s48, s51
    s_cmov_b32 s48, 0

    v_mfma_f32_16x16x32_bf16 v[16:19], v[40:43], v[48:51], v[16:19]
    v_mfma_f32_16x16x32_bf16 v[28:31], v[44:47], v[48:51], v[28:31]
    v_mfma_f32_16x16x32_bf16 v[20:23], v[40:43], v[52:55], v[20:23]
    v_mfma_f32_16x16x32_bf16 v[32:35], v[44:47], v[52:55], v[32:35]
    v_mfma_f32_16x16x32_bf16 v[24:27], v[40:43], v[56:59], v[24:27]
    v_mfma_f32_16x16x32_bf16 v[36:39], v[44:47], v[56:59], v[36:39]
    s_waitcnt vmcnt(4) lgkmcnt(0)
    s_barrier
    ds_read_b128 v[40:43], v10 offset:0
    ds_read_b128 v[44:47], v10 offset:2048
    ds_read_b64_tr_b16 v[48:49], v12 offset:24576
    ds_read_b64_tr_b16 v[50:51], v12 offset:25088
    ds_read_b64_tr_b16 v[52:53], v13 offset:24576
    ds_read_b64_tr_b16 v[54:55], v13 offset:25088
    ds_read_b64_tr_b16 v[56:57], v14 offset:24576
    ds_read_b64_tr_b16 v[58:59], v14 offset:25088
    s_cmp_ge_u32 s10, 6
    s_mov_b32 s29, 12288
    s_cmov_b32 s29, 16384
    s_add_u32 m0, s29, s28
    s_add_u32 s29, s29, s28
    buffer_load_dwordx4 v8, s[16:19], s48 offen lds
    s_add_u32 m0, s29, 1024
    s_nop 0
    buffer_load_dwordx4 v9, s[16:19], s48 offen lds
    s_add_u32 s48, s48, s49
    s_cmp_eq_u32 s48, s51
    s_cmov_b32 s48, 0

    v_mfma_f32_16x16x32_bf16 v[16:19], v[60:63], v[68:71], v[16:19]
    v_mfma_f32_16x16x32_bf16 v[28:31], v[64:67], v[68:71], v[28:31]
    v_mfma_f32_16x16x32_bf16 v[20:23], v[60:63], v[72:75], v[20:23]
    v_mfma_f32_16x16x32_bf16 v[32:35], v[64:67], v[72:75], v[32:35]
    v_mfma_f32_16x16x32_bf16 v[24:27], v[60:63], v[76:79], v[24:27]
    v_mfma_f32_16x16x32_bf16 v[36:39], v[64:67], v[76:79], v[36:39]
    s_waitcnt vmcnt(4) lgkmcnt(0)
    s_barrier
    ds_read_b128 v[60:63], v11 offset:0
    ds_read_b128 v[64:67], v11 offset:2048
    ds_read_b64_tr_b16 v[68:69], v12 offset:36864
    ds_read_b64_tr_b16 v[70:71], v12 offset:37376
    ds_read_b64_tr_b16 v[72:73], v13 offset:36864
    ds_read_b64_tr_b16 v[74:75], v13 offset:37376
    ds_read_b64_tr_b16 v[76:77], v14 offset:36864
    ds_read_b64_tr_b16 v[78:79], v14 offset:37376
    s_cmp_ge_u32 s10, 6
    s_mov_b32 s29, 24576
    s_cmov_b32 s29, 20480
    s_add_u32 m0, s29, s28
    s_add_u32 s29, s29, s28
    buffer_load_dwordx4 v8, s[16:19], s48 offen lds
    s_add_u32 m0, s29, 1024
    s_nop 0
    buffer_load_dwordx4 v9, s[16:19], s48 offen lds
    s_add_u32 s48, s48, s50
    s_cmp_eq_u32 s48, s51
    s_cmov_b32 s48, 0

    v_mfma_f32_16x16x32_bf16 v[16:19], v[40:43], v[48:51], v[16:19]
    v_mfma_f32_16x16x32_bf16 v[28:31], v[44:47], v[48:51], v[28:31]
    v_mfma_f32_16x16x32_bf16 v[20:23], v[40:43], v[52:55], v[20:23]
    v_mfma_f32_16x16x32_bf16 v[32:35], v[44:47], v[52:55], v[32:35]
    v_mfma_f32_16x16x32_bf16 v[24:27], v[40:43], v[56:59], v[24:27]
    v_mfma_f32_16x16x32_bf16 v[36:39], v[44:47], v[56:59], v[36:39]
    s_waitcnt vmcnt(4) lgkmcnt(0)
    s_barrier
    ds_read_b128 v[40:43], v10 offset:8192
    ds_read_b128 v[44:47], v10 offset:10240
    ds_read_b64_tr_b16 v[48:49], v12 offset:0
    ds_read_b64_tr_b16 v[50:51], v12 offset:512
    ds_read_b64_tr_b16 v[52:53], v13 offset:0
    ds_read_b64_tr_b16 v[54:55], v13 offset:512
    ds_read_b64_tr_b16 v[56:57], v14 offset:0
    ds_read_b64_tr_b16 v[58:59], v14 offset:512
    s_cmp_ge_u32 s10, 6
    s_mov_b32 s29, 36864
    s_cmov_b32 s29, 0
    s_add_u32 m0, s29, s28
    s_add_u32 s29, s29, s28
    buffer_load_dwordx4 v8, s[16:19], s48 offen lds
    s_add_u32 m0, s29, 1024
    s_nop 0
    buffer_load_dwordx4 v9, s[16:19], s48 offen lds
    s_add_u32 s48, s48, s49
    s_cmp_eq_u32 s48, s51
    s_cmov_b32 s48, 0

    v_mfma_f32_16x16x32_bf16 v[16:19], v[60:63], v[68:71], v[16:19]
    v_mfma_f32_16x16x32_bf16 v[28:31], v[64:67], v[68:71], v[28:31]
    v_mfma_f32_16x16x32_bf16 v[20:23], v[60:63], v[72:75], v[20:23]
    v_mfma_f32_16x16x32_bf16 v[32:35], v[64:67], v[72:75], v[32:35]
    v_mfma_f32_16x16x32_bf16 v[24:27], v[60:63], v[76:79], v[24:27]
    v_mfma_f32_16x16x32_bf16 v[36:39], v[64:67], v[76:79], v[36:39]
    s_waitcnt vmcnt(4) lgkmcnt(0)
    s_barrier
    ds_read_b128 v[60:63], v11 offset:8192
    ds_read_b128 v[64:67], v11 offset:10240
    ds_read_b64_tr_b16 v[68:69], v12 offset:12288
    ds_read_b64_tr_b16 v[70:71], v12 offset:12800
    ds_read_b64_tr_b16 v[72:73], v13 offset:12288
    ds_read_b64_tr_b16 v[74:75], v13 offset:12800
    ds_read_b64_tr_b16 v[76:77], v14 offset:12288
    ds_read_b64_tr_b16 v[78:79], v14 offset:12800
    s_cmp_ge_u32 s10, 6
    s_mov_b32 s29, 0
    s_cmov_b32 s29, 4096
    s_add_u32 m0, s29, s28
    s_add_u32 s29, s29, s28
    buffer_load_dwordx4 v8, s[16:19], s48 offen lds
    s_add_u32 m0, s29, 1024
    s_nop 0
    buffer_load_dwordx4 v9, s[16:19], s48 offen lds
    s_add_u32 s48, s48, s50
    s_cmp_eq_u32 s48, s51
    s_cmov_b32 s48, 0

    v_mfma_f32_16x16x32_bf16 v[16:19], v[40:43], v[48:51], v[16:19]
    v_mfma_f32_16x16x32_bf16 v[28:31], v[44:47], v[48:51], v[28:31]
    v_mfma_f32_16x16x32_bf16 v[20:23], v[40:43], v[52:55], v[20:23]
    v_mfma_f32_16x16x32_bf16 v[32:35], v[44:47], v[52:55], v[32:35]
    v_mfma_f32_16x16x32_bf16 v[24:27], v[40:43], v[56:59], v[24:27]
    v_mfma_f32_16x16x32_bf16 v[36:39], v[44:47], v[56:59], v[36:39]
    s_waitcnt vmcnt(4) lgkmcnt(0)
    s_barrier
    ds_read_b128 v[40:43], v10 offset:16384
    ds_read_b128 v[44:47], v10 offset:18432
    ds_read_b64_tr_b16 v[48:49], v12 offset:24576
    ds_read_b64_tr_b16 v[50:51], v12 offset:25088
    ds_read_b64_tr_b16 v[52:53], v13 offset:24576
    ds_read_b64_tr_b16 v[54:55], v13 offset:25088
    ds_read_b64_tr_b16 v[56:57], v14 offset:24576
    ds_read_b64_tr_b16 v[58:59], v14 offset:25088
    s_cmp_ge_u32 s10, 6
    s_cbranch_scc1 QKV_skip3
    s_cmp_ge_u32 s10, 6
    s_mov_b32 s29, 12288
    s_cmov_b32 s29, 0
    s_add_u32 m0, s29, s28
    s_add_u32 s29, s29, s28
    buffer_load_dwordx4 v8, s[16:19], s48 offen lds
    s_add_u32 m0, s29, 1024
    s_nop 0
    buffer_load_dwordx4 v9, s[16:19], s48 offen lds
    s_add_u32 s48, s48, s49
    s_cmp_eq_u32 s48, s51
    s_cmov_b32 s48, 0

QKV_skip3:
    v_mfma_f32_16x16x32_bf16 v[16:19], v[60:63], v[68:71], v[16:19]
    v_mfma_f32_16x16x32_bf16 v[28:31], v[64:67], v[68:71], v[28:31]
    v_mfma_f32_16x16x32_bf16 v[20:23], v[60:63], v[72:75], v[20:23]
    v_mfma_f32_16x16x32_bf16 v[32:35], v[64:67], v[72:75], v[32:35]
    v_mfma_f32_16x16x32_bf16 v[24:27], v[60:63], v[76:79], v[24:27]
    v_mfma_f32_16x16x32_bf16 v[36:39], v[64:67], v[76:79], v[36:39]
    s_waitcnt vmcnt(2) lgkmcnt(0)
    s_barrier
    ds_read_b128 v[60:63], v11 offset:16384
    ds_read_b128 v[64:67], v11 offset:18432
    ds_read_b64_tr_b16 v[68:69], v12 offset:36864
    ds_read_b64_tr_b16 v[70:71], v12 offset:37376
    ds_read_b64_tr_b16 v[72:73], v13 offset:36864
    ds_read_b64_tr_b16 v[74:75], v13 offset:37376
    ds_read_b64_tr_b16 v[76:77], v14 offset:36864
    ds_read_b64_tr_b16 v[78:79], v14 offset:37376
    v_mfma_f32_16x16x32_bf16 v[16:19], v[40:43], v[48:51], v[16:19]
    v_mfma_f32_16x16x32_bf16 v[28:31], v[44:47], v[48:51], v[28:31]
    v_mfma_f32_16x16x32_bf16 v[20:23], v[40:43], v[52:55], v[20:23]
    v_mfma_f32_16x16x32_bf16 v[32:35], v[44:47], v[52:55], v[32:35]
    v_mfma_f32_16x16x32_bf16 v[24:27], v[40:43], v[56:59], v[24:27]
    v_mfma_f32_16x16x32_bf16 v[36:39], v[44:47], v[56:59], v[36:39]
    s_waitcnt vmcnt(0) lgkmcnt(0)
    s_barrier
    ds_read_b128 v[40:43], v10 offset:0
    ds_read_b128 v[44:47], v10 offset:2048
    ds_read_b64_tr_b16 v[48:49], v12 offset:0
    ds_read_b64_tr_b16 v[50:51], v12 offset:512
    ds_read_b64_tr_b16 v[52:53], v13 offset:0
    ds_read_b64_tr_b16 v[54:55], v13 offset:512
    ds_read_b64_tr_b16 v[56:57], v14 offset:0
    ds_read_b64_tr_b16 v[58:59], v14 offset:512
    v_mfma_f32_16x16x32_bf16 v[16:19], v[60:63], v[68:71], v[16:19]
    v_mfma_f32_16x16x32_bf16 v[28:31], v[64:67], v[68:71], v[28:31]
    v_mfma_f32_16x16x32_bf16 v[20:23], v[60:63], v[72:75], v[20:23]
    v_mfma_f32_16x16x32_bf16 v[32:35], v[64:67], v[72:75], v[32:35]
    v_mfma_f32_16x16x32_bf16 v[24:27], v[60:63], v[76:79], v[24:27]
    v_mfma_f32_16x16x32_bf16 v[36:39], v[64:67], v[76:79], v[36:39]
    s_mov_b64 exec, s[52:53]
    ds_write_b64 v80, v[96:97] offset:128
    ds_write_b64 v80, v[96:97] offset:1152
    s_mov_b64 exec, s[54:55]
    ds_write_b64 v81, v[96:97] offset:128
    ds_write_b64 v81, v[96:97] offset:1152
    s_mov_b64 exec, s[56:57]
    ds_write_b64 v82, v[96:97] offset:128
    ds_write_b64 v82, v[96:97] offset:1152
    s_mov_b64 exec, -1
    s_waitcnt vmcnt(0) lgkmcnt(0)
    s_barrier
    ds_read_b128 v[60:63], v11 offset:0
    ds_read_b128 v[64:67], v11 offset:2048
    ds_read_b64_tr_b16 v[68:69], v12 offset:12288
    ds_read_b64_tr_b16 v[70:71], v12 offset:12800
    ds_read_b64_tr_b16 v[72:73], v13 offset:12288
    ds_read_b64_tr_b16 v[74:75], v13 offset:12800
    ds_read_b64_tr_b16 v[76:77], v14 offset:12288
    ds_read_b64_tr_b16 v[78:79], v14 offset:12800
    v_mfma_f32_16x16x32_bf16 v[16:19], v[40:43], v[48:51], v[16:19]
    v_mfma_f32_16x16x32_bf16 v[28:31], v[44:47], v[48:51], v[28:31]
    v_mfma_f32_16x16x32_bf16 v[20:23], v[40:43], v[52:55], v[20:23]
    v_mfma_f32_16x16x32_bf16 v[32:35], v[44:47], v[52:55], v[32:35]
    v_mfma_f32_16x16x32_bf16 v[24:27], v[40:43], v[56:59], v[24:27]
    v_mfma_f32_16x16x32_bf16 v[36:39], v[44:47], v[56:59], v[36:39]
    s_waitcnt lgkmcnt(0)
    v_mfma_f32_16x16x32_bf16 v[16:19], v[60:63], v[68:71], v[16:19]
    v_mfma_f32_16x16x32_bf16 v[28:31], v[64:67], v[68:71], v[28:31]
    v_mfma_f32_16x16x32_bf16 v[20:23], v[60:63], v[72:75], v[20:23]
    v_mfma_f32_16x16x32_bf16 v[32:35], v[64:67], v[72:75], v[32:35]
    v_mfma_f32_16x16x32_bf16 v[24:27], v[60:63], v[76:79], v[24:27]
    v_mfma_f32_16x16x32_bf16 v[36:39], v[64:67], v[76:79], v[36:39]
    s_nop 3
    v_cvt_pk_bf16_f32 v44, v16, v17
    v_cvt_pk_bf16_f32 v45, v18, v19
    ds_write_b64 v80, v[44:45] offset:0
    v_cvt_pk_bf16_f32 v46, v28, v29
    v_cvt_pk_bf16_f32 v47, v30, v31
    ds_write_b64 v80, v[46:47] offset:1024
    v_cvt_pk_bf16_f32 v48, v20, v21
    v_cvt_pk_bf16_f32 v49, v22, v23
    ds_write_b64 v81, v[48:49] offset:0
    v_cvt_pk_bf16_f32 v50, v32, v33
    v_cvt_pk_bf16_f32 v51, v34, v35
    ds_write_b64 v81, v[50:51] offset:1024
    v_cvt_pk_bf16_f32 v52, v24, v25
    v_cvt_pk_bf16_f32 v53, v26, v27
    ds_write_b64 v82, v[52:53] offset:0
    v_cvt_pk_bf16_f32 v54, v36, v37
    v_cvt_pk_bf16_f32 v55, v38, v39
    ds_write_b64 v82, v[54:55] offset:1024
QKV_end:
    s_waitcnt lgkmcnt(0)
    s_barrier
    ds_read_b128 v[16:19], v83
    ds_read_b128 v[24:27], v83 offset:2048
    ds_read_b128 v[20:23], v83 offset:1024
    ds_read_b128 v[28:31], v83 offset:3072
    s_mov_b64 exec, s[32:33]
    s_waitcnt lgkmcnt(2)

    buffer_store_dwordx4 v[16:19], v5, s[24:27], s42 offen sc1
    buffer_store_dwordx4 v[24:27], v5, s[24:27], s42 offen offset:2048 sc1
    s_mov_b64 exec, s[34:35]
    s_waitcnt lgkmcnt(0)
    buffer_store_dwordx4 v[20:23], v5, s[24:27], s42 offen offset:1024 sc1
    buffer_store_dwordx4 v[28:31], v5, s[24:27], s42 offen offset:3072 sc1
    s_mov_b64 exec, -1

    s_memrealtime s[90:91]
    s_lshl_b32 s86, s3, 7
    s_add_u32 s86, s86, 16777216
    v_mov_b32 v4, 0
    s_waitcnt vmcnt(0) lgkmcnt(0)
    v_mov_b32 v2, s90
    v_mov_b32 v3, s91
    s_barrier
    s_cmp_lg_u32 s10, 7
    s_cbranch_scc1 SIG_skip1
    s_mov_b64 exec, 1
    buffer_store_dwordx2 v[2:3], v4, s[24:27], s86 offen sc1
    s_mov_b64 exec, -1

SIG_skip1:
    s_cmp_lg_u32 s83, 0
    s_cbranch_scc1 HELP_NEXT

A_ATT:
    s_setprio 1
    s_mov_b32 s2, s82

    s_and_b32 s11, s2, 15
    s_lshr_b32 s12, s2, 4
    s_mul_i32 s13, s11, 28
    s_add_u32 s14, s10, 1
    s_mul_i32 s14, s14, 448
    s_cmp_eq_u32 s10, 2
    s_cmov_b32 s14, 0
    s_cselect_b32 s15, 1, 31
    s_cselect_b32 s16, s12, 0
    s_lshl_b32 s16, s16, 1
    s_add_u32 s13, s13, s14
    v_lshrrev_b32 v3, 5, v1
    v_mul_u32_u24 v3, 27, v3
    v_add_u32 v3, s13, v3
    v_mul_u32_u24 v3, 1366, v3
    v_lshrrev_b32 v3, 18, v3
    v_and_b32 v4, s15, v1
    v_add_u32 v4, s16, v4
    v_lshl_add_u32 v3, v3, 5, v4
    v_lshlrev_b32 v3, 7, v3
    v_add_u32 v3, 16777216, v3

    s_getreg_b32 s6, hwreg(HW_REG_XCC_ID)
    s_bitcmp1_b32 s6, 0
    s_movk_i32 s6, 900
    s_cmovk_i32 s6, 800

A_dly:
    s_sleep 2
    s_memrealtime s[4:5]
    s_waitcnt lgkmcnt(0)
    s_sub_u32 s4, s4, s84
    s_cmp_lt_u32 s4, s6
    s_cbranch_scc1 A_dly

    s_cmp_ge_u32 s10, 4
    s_cbranch_scc1 W_oth2
    s_lshl_b32 s91, s10, 2
    s_add_u32 s91, s91, 81904
    v_mov_b32 v2, s91
    s_mov_b32 s90, 0
    v_mov_b32 v4, 0
    s_cmp_ge_u32 s10, 3
    s_cbranch_scc1 W_ok2
    s_cmp_eq_u32 s83, 4
    s_cbranch_scc1 W_ok2
    v_mov_b32 v4, s85

W_spin2:
    buffer_load_dwordx2 v[6:7], v3, s[24:27], 0 offen sc1
    s_add_u32 s90, s90, 1
    s_waitcnt vmcnt(0)
    v_subrev_co_u32 v6, vcc, s84, v6
    v_subb_co_u32 v7, vcc, v7, v4, vcc
    v_lshrrev_b32 v6, 24, v6
    v_or_b32 v6, v6, v7
    v_cmpx_ne_u32 vcc, 0, v6
    s_nop 1
    s_cbranch_execz W_pass2
    s_sleep 6
    s_cmp_lt_u32 s90, 20000
    s_cbranch_scc1 W_spin2
    s_mov_b64 exec, -1
    v_mov_b32 v4, 1
    s_branch W_ok2

W_pass2:
    s_mov_b64 exec, -1
    v_mov_b32 v4, 0

W_ok2:
    s_mov_b64 exec, 1
    ds_write_b32 v2, v4
    s_mov_b64 exec, -1
    s_waitcnt lgkmcnt(0)

W_oth2:
    v_mov_b32 v2, 81904
    s_waitcnt vmcnt(0)
    s_barrier
    ds_read_b128 v[6:9], v2
    s_mov_b32 s83, 0
    s_waitcnt lgkmcnt(0)
    v_or3_b32 v6, v6, v7, v8
    v_or_b32 v6, v6, v9
    s_nop 0
    v_readfirstlane_b32 s91, v6
    s_cmp_lg_u32 s91, 0
    s_cbranch_scc1 HELP1

ATT_ENTRY:
    s_mov_b32 s3, s2
    v_and_b32 v3, 31, v1
    v_lshrrev_b32 v4, 5, v1
    s_mov_b32 s30, 0
    s_mov_b32 s31, -1
    s_and_b32 s11, s2, 15
    s_lshr_b32 s12, s2, 4
    s_lshr_b32 s13, s10, 2
    s_and_b32 s14, s10, 3
    s_lshl_b32 s15, s11, 6
    s_lshl_b32 s16, s12, 2
    s_add_u32 s16, s16, s14
    s_add_u32 s16, s16, s15
    s_lshl_b32 s16, s16, 11
    buffer_load_dwordx4 v[8:11], v5, s[24:27], s16 offen
    buffer_load_dwordx4 v[12:15], v5, s[24:27], s16 offen offset:1024
    s_lshl_b32 s17, s13, 5
    s_add_u32 s17, s17, s15
    s_lshl_b32 s17, s17, 11
    s_add_u32 s32, s17, 2097152
    s_add_u32 s33, s17, 4194304
    buffer_load_dwordx4 v[32:35], v5, s[24:27], s32 offen
    buffer_load_dwordx4 v[36:39], v5, s[24:27], s32 offen offset:1024
    buffer_load_dwordx4 v[16:19], v5, s[24:27], s32 offen offset:2048
    buffer_load_dwordx4 v[20:23], v5, s[24:27], s32 offen offset:3072
    buffer_load_dwordx4 v[24:27], v5, s[24:27], s33 offen
    s_lshl_b32 s18, s14, 11
    s_add_u32 s19, s32, 4096
    s_add_u32 s20, s33, -3072
    s_cmp_lt_u32 s14, 2
    s_cselect_b32 s19, s19, s20
    s_add_u32 s19, s19, s18
    s_lshl_b32 s20, s13, 13
    s_add_u32 s18, s18, s20
    v_add_u32 v6, s20, v5

    s_add_u32 s21, s18, 0
    s_mov_b32 m0, s21
    s_nop 0
    buffer_load_dwordx4 v5, s[24:27], s19 offen lds
    buffer_load_dwordx4 v5, s[24:27], s19 offen offset:1024 lds
    s_add_u32 s19, s19, 4096

    s_add_u32 s21, s18, 16384
    s_mov_b32 m0, s21
    s_nop 0
    buffer_load_dwordx4 v5, s[24:27], s19 offen lds
    buffer_load_dwordx4 v5, s[24:27], s19 offen offset:1024 lds
    s_add_u32 s19, s19, 4096

    s_add_u32 s21, s18, 32768
    s_mov_b32 m0, s21
    s_nop 0
    buffer_load_dwordx4 v5, s[24:27], s19 offen lds
    buffer_load_dwordx4 v5, s[24:27], s19 offen offset:1024 lds
    s_add_u32 s19, s19, 4096

    v_lshrrev_b32 v96, 3, v1
    v_mul_u32_u24 v96, 896, v96
    v_and_b32 v97, 7, v1
    v_bfe_u32 v98, v1, 4, 1
    v_lshlrev_b32 v98, 1, v98
    v_xor_b32 v97, v97, v98
    s_and_b32 s48, s10, 1
    s_lshl_b32 s48, s48, 2
    v_xor_b32 v97, s48, v97
    v_lshl_add_u32 v96, v97, 4, v96
    s_mul_i32 s48, s14, 7168
    s_lshr_b32 s49, s82, 5
    s_min_u32 s49, s49, 6
    s_lshl_b32 s49, s49, 7
    s_add_u32 s48, s48, s49
    s_mul_i32 s49, s13, 25088
    s_add_u32 s48, s48, s49
    s_lshl_b32 s49, s14, 10
    s_lshl_b32 s50, s13, 12
    s_add_u32 s49, s49, s50

    s_mov_b32 s44, s68
    s_mov_b32 s45, s69
    s_mov_b32 s46, 0x62000
    s_mov_b32 s47, 0x00020000
    s_cmp_lt_u32 s82, 224
    s_cselect_b32 s46, s46, 0

    v_mov_b32 v40, 0
    v_mov_b32 v41, 0
    v_mov_b32 v42, 0
    v_mov_b32 v43, 0
    v_mov_b32 v44, 0
    v_mov_b32 v45, 0
    v_mov_b32 v46, 0
    v_mov_b32 v47, 0
    v_mov_b32 v48, 0
    v_mov_b32 v49, 0
    v_mov_b32 v50, 0
    v_mov_b32 v51, 0
    v_mov_b32 v52, 0
    v_mov_b32 v53, 0
    v_mov_b32 v54, 0
    v_mov_b32 v55, 0
    v_mov_b32 v28, 0
    v_mov_b32 v29, 0
    v_mov_b32 v30, 0
    v_mov_b32 v31, 0
    s_mov_b32 s22, 0x5f800000
    s_mov_b32 s23, 0
    s_waitcnt vmcnt(6)
    v_mfma_f32_32x32x16_bf16 v[56:71], v[32:35], v[8:11], 0
    v_mfma_f32_32x32x16_bf16 v[56:71], v[36:39], v[12:15], v[56:71]
    s_nop 15
    v_max3_f32 v89, v56, v57, v58
    v_max3_f32 v90, v59, v60, v61
    v_max3_f32 v89, v89, v62, v63
    v_max3_f32 v90, v90, v64, v65
    v_max3_f32 v89, v89, v66, v67
    v_max3_f32 v90, v90, v68, v69
    v_max3_f32 v89, v89, v70, v71
    v_max_f32 v89, v89, v90
    v_mov_b32 v90, v89
    s_nop 1
    v_permlane32_swap_b32 v89, v90
    s_nop 1
    v_max_f32 v89, v89, v90
    v_cvt_pk_bf16_f32 v90, v89, v89
    v_and_b32 v88, 0xffff0000, v90
    v_lshrrev_b32 v90, 16, v88
    v_xor_b32 v90, 0x8000, v90
    v_cndmask_b32 v14, v14, v90, s[30:31]

    v_sub_f32 v56, v56, v88
    v_sub_f32 v57, v57, v88
    v_sub_f32 v58, v58, v88
    v_sub_f32 v59, v59, v88
    v_sub_f32 v60, v60, v88
    v_sub_f32 v61, v61, v88
    v_sub_f32 v62, v62, v88
    v_sub_f32 v63, v63, v88
    v_sub_f32 v64, v64, v88
    v_sub_f32 v65, v65, v88
    v_sub_f32 v66, v66, v88
    v_sub_f32 v67, v67, v88
    v_sub_f32 v68, v68, v88
    v_sub_f32 v69, v69, v88
    v_sub_f32 v70, v70, v88
    v_sub_f32 v71, v71, v88
    v_mov_b32 v36, 0
    v_mov_b32 v37, 0
    v_mov_b32 v38, 0
    v_mov_b32 v39, 0
ATT_loop:
    s_waitcnt vmcnt(4) lgkmcnt(0)
    s_barrier
    s_add_u32 s21, s18, 49152
    s_mov_b32 m0, s21
    s_nop 0
    buffer_load_dwordx4 v5, s[24:27], s19 offen lds
    buffer_load_dwordx4 v5, s[24:27], s19 offen offset:1024 lds
    s_add_u32 s19, s19, 4096

    v_cmp_lt_f32 vcc, s22, v52
    s_waitcnt lgkmcnt(3)
    s_nop 1
    s_cbranch_vccnz ATT_rareL0
    v_mfma_f32_32x32x16_bf16 v[40:55], v[28:31], v[36:39], v[40:55]
ATT_backL0:
    ds_read_b128 v[28:31], v6 offset:4096
    v_exp_f32 v56, v56
    v_exp_f32 v57, v57
    v_exp_f32 v58, v58
    v_cvt_pk_bf16_f32 v32, v56, v57
    v_exp_f32 v59, v59
    s_waitcnt lgkmcnt(3)
    v_mfma_f32_32x32x16_bf16 v[72:87], v[16:19], v[8:11], 0
    ds_read_b128 v[16:19], v6 offset:0
    v_exp_f32 v60, v60
    v_cvt_pk_bf16_f32 v33, v58, v59
    v_exp_f32 v61, v61
    v_exp_f32 v62, v62
    v_cvt_pk_bf16_f32 v34, v60, v61
    v_exp_f32 v63, v63
    s_waitcnt lgkmcnt(3)
    v_mfma_f32_32x32x16_bf16 v[72:87], v[20:23], v[12:15], v[72:87]
    ds_read_b128 v[20:23], v6 offset:1024
    v_exp_f32 v64, v64
    v_cvt_pk_bf16_f32 v35, v62, v63
    v_exp_f32 v65, v65
    v_exp_f32 v66, v66
    v_cvt_pk_bf16_f32 v36, v64, v65
    v_exp_f32 v67, v67
    s_waitcnt lgkmcnt(3)
    v_mfma_f32_32x32x16_bf16 v[40:55], v[24:27], v[32:35], v[40:55]
    ds_read_b128 v[24:27], v6 offset:5120
    v_exp_f32 v68, v68
    v_cvt_pk_bf16_f32 v37, v66, v67
    v_exp_f32 v69, v69
    v_exp_f32 v70, v70
    v_cvt_pk_bf16_f32 v38, v68, v69
    v_exp_f32 v71, v71
    s_nop 0
    v_cvt_pk_bf16_f32 v39, v70, v71
    s_waitcnt lgkmcnt(3)
    s_nop 0
    v_mfma_f32_32x32x16_bf16 v[40:55], v[28:31], v[36:39], v[40:55]
    ds_read_b128 v[28:31], v6 offset:6144
    v_exp_f32 v72, v72
    v_exp_f32 v73, v73
    v_exp_f32 v74, v74
    v_cvt_pk_bf16_f32 v32, v72, v73
    v_exp_f32 v75, v75
    s_waitcnt lgkmcnt(3)
    v_mfma_f32_32x32x16_bf16 v[56:71], v[16:19], v[8:11], 0
    ds_read_b128 v[16:19], v6 offset:2048
    v_exp_f32 v76, v76
    v_cvt_pk_bf16_f32 v33, v74, v75
    v_exp_f32 v77, v77
    v_exp_f32 v78, v78
    v_cvt_pk_bf16_f32 v34, v76, v77
    v_exp_f32 v79, v79
    s_waitcnt lgkmcnt(3)
    v_mfma_f32_32x32x16_bf16 v[56:71], v[20:23], v[12:15], v[56:71]
    ds_read_b128 v[20:23], v6 offset:3072
    v_exp_f32 v80, v80
    v_cvt_pk_bf16_f32 v35, v78, v79
    v_exp_f32 v81, v81
    v_exp_f32 v82, v82
    v_cvt_pk_bf16_f32 v36, v80, v81
    v_exp_f32 v83, v83
    s_waitcnt lgkmcnt(3)
    v_mfma_f32_32x32x16_bf16 v[40:55], v[24:27], v[32:35], v[40:55]
    ds_read_b128 v[24:27], v6 offset:7168
    v_exp_f32 v84, v84
    v_cvt_pk_bf16_f32 v37, v82, v83
    v_exp_f32 v85, v85
    v_exp_f32 v86, v86
    v_cvt_pk_bf16_f32 v38, v84, v85
    v_exp_f32 v87, v87
    s_nop 0
    v_cvt_pk_bf16_f32 v39, v86, v87
    s_waitcnt vmcnt(4) lgkmcnt(0)
    s_barrier
    s_add_u32 s21, s18, 0
    s_mov_b32 m0, s21
    s_nop 0
    buffer_load_dwordx4 v5, s[24:27], s19 offen lds
    buffer_load_dwordx4 v5, s[24:27], s19 offen offset:1024 lds
    s_add_u32 s19, s19, 4096

    v_cmp_lt_f32 vcc, s22, v52
    s_waitcnt lgkmcnt(3)
    s_nop 1
    s_cbranch_vccnz ATT_rareL2
    v_mfma_f32_32x32x16_bf16 v[40:55], v[28:31], v[36:39], v[40:55]
ATT_backL2:
    ds_read_b128 v[28:31], v6 offset:20480
    v_exp_f32 v56, v56
    v_exp_f32 v57, v57
    v_exp_f32 v58, v58
    v_cvt_pk_bf16_f32 v32, v56, v57
    v_exp_f32 v59, v59
    s_waitcnt lgkmcnt(3)
    v_mfma_f32_32x32x16_bf16 v[72:87], v[16:19], v[8:11], 0
    ds_read_b128 v[16:19], v6 offset:16384
    v_exp_f32 v60, v60
    v_cvt_pk_bf16_f32 v33, v58, v59
    v_exp_f32 v61, v61
    v_exp_f32 v62, v62
    v_cvt_pk_bf16_f32 v34, v60, v61
    v_exp_f32 v63, v63
    s_waitcnt lgkmcnt(3)
    v_mfma_f32_32x32x16_bf16 v[72:87], v[20:23], v[12:15], v[72:87]
    ds_read_b128 v[20:23], v6 offset:17408
    v_exp_f32 v64, v64
    v_cvt_pk_bf16_f32 v35, v62, v63
    v_exp_f32 v65, v65
    v_exp_f32 v66, v66
    v_cvt_pk_bf16_f32 v36, v64, v65
    v_exp_f32 v67, v67
    s_waitcnt lgkmcnt(3)
    v_mfma_f32_32x32x16_bf16 v[40:55], v[24:27], v[32:35], v[40:55]
    ds_read_b128 v[24:27], v6 offset:21504
    v_exp_f32 v68, v68
    v_cvt_pk_bf16_f32 v37, v66, v67
    v_exp_f32 v69, v69
    v_exp_f32 v70, v70
    v_cvt_pk_bf16_f32 v38, v68, v69
    v_exp_f32 v71, v71
    s_nop 0
    v_cvt_pk_bf16_f32 v39, v70, v71
    s_waitcnt lgkmcnt(3)
    s_nop 0
    v_mfma_f32_32x32x16_bf16 v[40:55], v[28:31], v[36:39], v[40:55]
    ds_read_b128 v[28:31], v6 offset:22528
    v_exp_f32 v72, v72
    v_exp_f32 v73, v73
    v_exp_f32 v74, v74
    v_cvt_pk_bf16_f32 v32, v72, v73
    v_exp_f32 v75, v75
    s_waitcnt lgkmcnt(3)
    v_mfma_f32_32x32x16_bf16 v[56:71], v[16:19], v[8:11], 0
    ds_read_b128 v[16:19], v6 offset:18432
    v_exp_f32 v76, v76
    v_cvt_pk_bf16_f32 v33, v74, v75
    v_exp_f32 v77, v77
    v_exp_f32 v78, v78
    v_cvt_pk_bf16_f32 v34, v76, v77
    v_exp_f32 v79, v79
    s_waitcnt lgkmcnt(3)
    v_mfma_f32_32x32x16_bf16 v[56:71], v[20:23], v[12:15], v[56:71]
    ds_read_b128 v[20:23], v6 offset:19456
    v_exp_f32 v80, v80
    v_cvt_pk_bf16_f32 v35, v78, v79
    v_exp_f32 v81, v81
    v_exp_f32 v82, v82
    v_cvt_pk_bf16_f32 v36, v80, v81
    v_exp_f32 v83, v83
    s_waitcnt lgkmcnt(3)
    v_mfma_f32_32x32x16_bf16 v[40:55], v[24:27], v[32:35], v[40:55]
    ds_read_b128 v[24:27], v6 offset:23552
    v_exp_f32 v84, v84
    v_cvt_pk_bf16_f32 v37, v82, v83
    v_exp_f32 v85, v85
    v_exp_f32 v86, v86
    v_cvt_pk_bf16_f32 v38, v84, v85
    v_exp_f32 v87, v87
    s_nop 0
    v_cvt_pk_bf16_f32 v39, v86, v87
    s_waitcnt vmcnt(4) lgkmcnt(0)
    s_barrier
    s_add_u32 s21, s18, 16384
    s_mov_b32 m0, s21
    s_nop 0
    buffer_load_dwordx4 v5, s[24:27], s19 offen lds
    buffer_load_dwordx4 v5, s[24:27], s19 offen offset:1024 lds
    s_add_u32 s19, s19, 4096

    v_cmp_lt_f32 vcc, s22, v52
    s_waitcnt lgkmcnt(3)
    s_nop 1
    s_cbranch_vccnz ATT_rareL4
    v_mfma_f32_32x32x16_bf16 v[40:55], v[28:31], v[36:39], v[40:55]
ATT_backL4:
    ds_read_b128 v[28:31], v6 offset:36864
    v_exp_f32 v56, v56
    v_exp_f32 v57, v57
    v_exp_f32 v58, v58
    v_cvt_pk_bf16_f32 v32, v56, v57
    v_exp_f32 v59, v59
    s_waitcnt lgkmcnt(3)
    v_mfma_f32_32x32x16_bf16 v[72:87], v[16:19], v[8:11], 0
    ds_read_b128 v[16:19], v6 offset:32768
    v_exp_f32 v60, v60
    v_cvt_pk_bf16_f32 v33, v58, v59
    v_exp_f32 v61, v61
    v_exp_f32 v62, v62
    v_cvt_pk_bf16_f32 v34, v60, v61
    v_exp_f32 v63, v63
    s_waitcnt lgkmcnt(3)
    v_mfma_f32_32x32x16_bf16 v[72:87], v[20:23], v[12:15], v[72:87]
    ds_read_b128 v[20:23], v6 offset:33792
    v_exp_f32 v64, v64
    v_cvt_pk_bf16_f32 v35, v62, v63
    v_exp_f32 v65, v65
    v_exp_f32 v66, v66
    v_cvt_pk_bf16_f32 v36, v64, v65
    v_exp_f32 v67, v67
    s_waitcnt lgkmcnt(3)
    v_mfma_f32_32x32x16_bf16 v[40:55], v[24:27], v[32:35], v[40:55]
    ds_read_b128 v[24:27], v6 offset:37888
    v_exp_f32 v68, v68
    v_cvt_pk_bf16_f32 v37, v66, v67
    v_exp_f32 v69, v69
    v_exp_f32 v70, v70
    v_cvt_pk_bf16_f32 v38, v68, v69
    v_exp_f32 v71, v71
    s_nop 0
    v_cvt_pk_bf16_f32 v39, v70, v71
    s_waitcnt lgkmcnt(3)
    s_nop 0
    v_mfma_f32_32x32x16_bf16 v[40:55], v[28:31], v[36:39], v[40:55]
    ds_read_b128 v[28:31], v6 offset:38912
    v_exp_f32 v72, v72
    v_exp_f32 v73, v73
    v_exp_f32 v74, v74
    v_cvt_pk_bf16_f32 v32, v72, v73
    v_exp_f32 v75, v75
    s_waitcnt lgkmcnt(3)
    v_mfma_f32_32x32x16_bf16 v[56:71], v[16:19], v[8:11], 0
    ds_read_b128 v[16:19], v6 offset:34816
    v_exp_f32 v76, v76
    v_cvt_pk_bf16_f32 v33, v74, v75
    v_exp_f32 v77, v77
    v_exp_f32 v78, v78
    v_cvt_pk_bf16_f32 v34, v76, v77
    v_exp_f32 v79, v79
    s_waitcnt lgkmcnt(3)
    v_mfma_f32_32x32x16_bf16 v[56:71], v[20:23], v[12:15], v[56:71]
    ds_read_b128 v[20:23], v6 offset:35840
    v_exp_f32 v80, v80
    v_cvt_pk_bf16_f32 v35, v78, v79
    v_exp_f32 v81, v81
    v_exp_f32 v82, v82
    v_cvt_pk_bf16_f32 v36, v80, v81
    v_exp_f32 v83, v83
    s_waitcnt lgkmcnt(3)
    v_mfma_f32_32x32x16_bf16 v[40:55], v[24:27], v[32:35], v[40:55]
    ds_read_b128 v[24:27], v6 offset:39936
    v_exp_f32 v84, v84
    v_cvt_pk_bf16_f32 v37, v82, v83
    v_exp_f32 v85, v85
    v_exp_f32 v86, v86
    v_cvt_pk_bf16_f32 v38, v84, v85
    v_exp_f32 v87, v87
    s_nop 0
    v_cvt_pk_bf16_f32 v39, v86, v87
    s_waitcnt vmcnt(4) lgkmcnt(0)
    s_barrier
    s_add_u32 s21, s18, 32768
    s_mov_b32 m0, s21
    s_nop 0
    buffer_load_dwordx4 v5, s[24:27], s19 offen lds
    buffer_load_dwordx4 v5, s[24:27], s19 offen offset:1024 lds
    s_add_u32 s19, s19, 4096

    v_cmp_lt_f32 vcc, s22, v52
    s_waitcnt lgkmcnt(3)
    s_nop 1
    s_cbranch_vccnz ATT_rareL6
    v_mfma_f32_32x32x16_bf16 v[40:55], v[28:31], v[36:39], v[40:55]
ATT_backL6:
    ds_read_b128 v[28:31], v6 offset:53248
    v_exp_f32 v56, v56
    v_exp_f32 v57, v57
    v_exp_f32 v58, v58
    v_cvt_pk_bf16_f32 v32, v56, v57
    v_exp_f32 v59, v59
    s_waitcnt lgkmcnt(3)
    v_mfma_f32_32x32x16_bf16 v[72:87], v[16:19], v[8:11], 0
    ds_read_b128 v[16:19], v6 offset:49152
    v_exp_f32 v60, v60
    v_cvt_pk_bf16_f32 v33, v58, v59
    v_exp_f32 v61, v61
    v_exp_f32 v62, v62
    v_cvt_pk_bf16_f32 v34, v60, v61
    v_exp_f32 v63, v63
    s_waitcnt lgkmcnt(3)
    v_mfma_f32_32x32x16_bf16 v[72:87], v[20:23], v[12:15], v[72:87]
    ds_read_b128 v[20:23], v6 offset:50176
    v_exp_f32 v64, v64
    v_cvt_pk_bf16_f32 v35, v62, v63
    v_exp_f32 v65, v65
    v_exp_f32 v66, v66
    v_cvt_pk_bf16_f32 v36, v64, v65
    v_exp_f32 v67, v67
    s_waitcnt lgkmcnt(3)
    v_mfma_f32_32x32x16_bf16 v[40:55], v[24:27], v[32:35], v[40:55]
    ds_read_b128 v[24:27], v6 offset:54272
    v_exp_f32 v68, v68
    v_cvt_pk_bf16_f32 v37, v66, v67
    v_exp_f32 v69, v69
    v_exp_f32 v70, v70
    v_cvt_pk_bf16_f32 v38, v68, v69
    v_exp_f32 v71, v71
    s_nop 0
    v_cvt_pk_bf16_f32 v39, v70, v71
    s_waitcnt lgkmcnt(3)
    s_nop 0
    v_mfma_f32_32x32x16_bf16 v[40:55], v[28:31], v[36:39], v[40:55]
    ds_read_b128 v[28:31], v6 offset:55296
    v_exp_f32 v72, v72
    v_exp_f32 v73, v73
    v_exp_f32 v74, v74
    v_cvt_pk_bf16_f32 v32, v72, v73
    v_exp_f32 v75, v75
    s_waitcnt lgkmcnt(3)
    v_mfma_f32_32x32x16_bf16 v[56:71], v[16:19], v[8:11], 0
    ds_read_b128 v[16:19], v6 offset:51200
    v_exp_f32 v76, v76
    v_cvt_pk_bf16_f32 v33, v74, v75
    v_exp_f32 v77, v77
    v_exp_f32 v78, v78
    v_cvt_pk_bf16_f32 v34, v76, v77
    v_exp_f32 v79, v79
    s_waitcnt lgkmcnt(3)
    v_mfma_f32_32x32x16_bf16 v[56:71], v[20:23], v[12:15], v[56:71]
    ds_read_b128 v[20:23], v6 offset:52224
    v_exp_f32 v80, v80
    v_cvt_pk_bf16_f32 v35, v78, v79
    v_exp_f32 v81, v81
    v_exp_f32 v82, v82
    v_cvt_pk_bf16_f32 v36, v80, v81
    v_exp_f32 v83, v83
    s_waitcnt lgkmcnt(3)
    v_mfma_f32_32x32x16_bf16 v[40:55], v[24:27], v[32:35], v[40:55]
    ds_read_b128 v[24:27], v6 offset:56320
    v_exp_f32 v84, v84
    v_cvt_pk_bf16_f32 v37, v82, v83
    v_exp_f32 v85, v85
    v_exp_f32 v86, v86
    v_cvt_pk_bf16_f32 v38, v84, v85
    v_exp_f32 v87, v87
    s_nop 0
    v_cvt_pk_bf16_f32 v39, v86, v87
    s_add_u32 s23, s23, 1
    s_cmp_lt_u32 s23, 3
    s_cbranch_scc1 ATT_loop

    s_waitcnt vmcnt(4) lgkmcnt(0)
    s_barrier
    s_add_u32 s21, s18, 49152
    s_mov_b32 m0, s21
    s_nop 0
    buffer_load_dwordx4 v5, s[24:27], s19 offen lds
    buffer_load_dwordx4 v5, s[24:27], s19 offen offset:1024 lds
    s_add_u32 s19, s19, 4096

    s_add_u32 m0, s49, 65536
    s_add_u32 s50, s48, 301056
    buffer_load_dwordx4 v96, s[44:47], s50 offen lds

    s_add_u32 m0, s49, 73728
    s_add_u32 s50, s48, 351232
    buffer_load_dwordx4 v96, s[44:47], s50 offen lds

    v_cmp_lt_f32 vcc, s22, v52
    s_waitcnt lgkmcnt(3)
    s_nop 1
    s_cbranch_vccnz ATT_rareT0
    v_mfma_f32_32x32x16_bf16 v[40:55], v[28:31], v[36:39], v[40:55]
ATT_backT0:
    ds_read_b128 v[28:31], v6 offset:4096
    v_exp_f32 v56, v56
    v_exp_f32 v57, v57
    v_exp_f32 v58, v58
    v_cvt_pk_bf16_f32 v32, v56, v57
    v_exp_f32 v59, v59
    s_waitcnt lgkmcnt(3)
    v_mfma_f32_32x32x16_bf16 v[72:87], v[16:19], v[8:11], 0
    ds_read_b128 v[16:19], v6 offset:0
    v_exp_f32 v60, v60
    v_cvt_pk_bf16_f32 v33, v58, v59
    v_exp_f32 v61, v61
    v_exp_f32 v62, v62
    v_cvt_pk_bf16_f32 v34, v60, v61
    v_exp_f32 v63, v63
    s_waitcnt lgkmcnt(3)
    v_mfma_f32_32x32x16_bf16 v[72:87], v[20:23], v[12:15], v[72:87]
    ds_read_b128 v[20:23], v6 offset:1024
    v_exp_f32 v64, v64
    v_cvt_pk_bf16_f32 v35, v62, v63
    v_exp_f32 v65, v65
    v_exp_f32 v66, v66
    v_cvt_pk_bf16_f32 v36, v64, v65
    v_exp_f32 v67, v67
    s_waitcnt lgkmcnt(3)
    v_mfma_f32_32x32x16_bf16 v[40:55], v[24:27], v[32:35], v[40:55]
    ds_read_b128 v[24:27], v6 offset:5120
    v_exp_f32 v68, v68
    v_cvt_pk_bf16_f32 v37, v66, v67
    v_exp_f32 v69, v69
    v_exp_f32 v70, v70
    v_cvt_pk_bf16_f32 v38, v68, v69
    v_exp_f32 v71, v71
    s_nop 0
    v_cvt_pk_bf16_f32 v39, v70, v71
    s_waitcnt lgkmcnt(3)
    s_nop 0
    v_mfma_f32_32x32x16_bf16 v[40:55], v[28:31], v[36:39], v[40:55]
    ds_read_b128 v[28:31], v6 offset:6144
    v_exp_f32 v72, v72
    v_exp_f32 v73, v73
    v_exp_f32 v74, v74
    v_cvt_pk_bf16_f32 v32, v72, v73
    v_exp_f32 v75, v75
    s_waitcnt lgkmcnt(3)
    v_mfma_f32_32x32x16_bf16 v[56:71], v[16:19], v[8:11], 0
    ds_read_b128 v[16:19], v6 offset:2048
    v_exp_f32 v76, v76
    v_cvt_pk_bf16_f32 v33, v74, v75
    v_exp_f32 v77, v77
    v_exp_f32 v78, v78
    v_cvt_pk_bf16_f32 v34, v76, v77
    v_exp_f32 v79, v79
    s_waitcnt lgkmcnt(3)
    v_mfma_f32_32x32x16_bf16 v[56:71], v[20:23], v[12:15], v[56:71]
    ds_read_b128 v[20:23], v6 offset:3072
    v_exp_f32 v80, v80
    v_cvt_pk_bf16_f32 v35, v78, v79
    v_exp_f32 v81, v81
    v_exp_f32 v82, v82
    v_cvt_pk_bf16_f32 v36, v80, v81
    v_exp_f32 v83, v83
    s_waitcnt lgkmcnt(3)
    v_mfma_f32_32x32x16_bf16 v[40:55], v[24:27], v[32:35], v[40:55]
    ds_read_b128 v[24:27], v6 offset:7168
    v_exp_f32 v84, v84
    v_cvt_pk_bf16_f32 v37, v82, v83
    v_exp_f32 v85, v85
    v_exp_f32 v86, v86
    v_cvt_pk_bf16_f32 v38, v84, v85
    v_exp_f32 v87, v87
    s_nop 0
    v_cvt_pk_bf16_f32 v39, v86, v87
    s_waitcnt vmcnt(6) lgkmcnt(0)
    s_barrier
    s_add_u32 m0, s49, 0
    s_add_u32 s50, s48, 0
    buffer_load_dwordx4 v96, s[44:47], s50 offen lds

    s_add_u32 m0, s49, 8192
    s_add_u32 s50, s48, 50176
    buffer_load_dwordx4 v96, s[44:47], s50 offen lds

    v_cmp_lt_f32 vcc, s22, v52
    s_waitcnt lgkmcnt(3)
    s_nop 1
    s_cbranch_vccnz ATT_rareT2
    v_mfma_f32_32x32x16_bf16 v[40:55], v[28:31], v[36:39], v[40:55]
ATT_backT2:
    ds_read_b128 v[28:31], v6 offset:20480
    v_exp_f32 v56, v56
    v_exp_f32 v57, v57
    v_exp_f32 v58, v58
    v_cvt_pk_bf16_f32 v32, v56, v57
    v_exp_f32 v59, v59
    s_waitcnt lgkmcnt(3)
    v_mfma_f32_32x32x16_bf16 v[72:87], v[16:19], v[8:11], 0
    ds_read_b128 v[16:19], v6 offset:16384
    v_exp_f32 v60, v60
    v_cvt_pk_bf16_f32 v33, v58, v59
    v_exp_f32 v61, v61
    v_exp_f32 v62, v62
    v_cvt_pk_bf16_f32 v34, v60, v61
    v_exp_f32 v63, v63
    s_waitcnt lgkmcnt(3)
    v_mfma_f32_32x32x16_bf16 v[72:87], v[20:23], v[12:15], v[72:87]
    ds_read_b128 v[20:23], v6 offset:17408
    v_exp_f32 v64, v64
    v_cvt_pk_bf16_f32 v35, v62, v63
    v_exp_f32 v65, v65
    v_exp_f32 v66, v66
    v_cvt_pk_bf16_f32 v36, v64, v65
    v_exp_f32 v67, v67
    s_waitcnt lgkmcnt(3)
    v_mfma_f32_32x32x16_bf16 v[40:55], v[24:27], v[32:35], v[40:55]
    ds_read_b128 v[24:27], v6 offset:21504
    v_exp_f32 v68, v68
    v_cvt_pk_bf16_f32 v37, v66, v67
    v_exp_f32 v69, v69
    v_exp_f32 v70, v70
    v_cvt_pk_bf16_f32 v38, v68, v69
    v_exp_f32 v71, v71
    s_nop 0
    v_cvt_pk_bf16_f32 v39, v70, v71
    s_waitcnt lgkmcnt(3)
    s_nop 0
    v_mfma_f32_32x32x16_bf16 v[40:55], v[28:31], v[36:39], v[40:55]
    ds_read_b128 v[28:31], v6 offset:22528
    v_exp_f32 v72, v72
    v_exp_f32 v73, v73
    v_exp_f32 v74, v74
    v_cvt_pk_bf16_f32 v32, v72, v73
    v_exp_f32 v75, v75
    s_waitcnt lgkmcnt(3)
    v_mfma_f32_32x32x16_bf16 v[56:71], v[16:19], v[8:11], 0
    ds_read_b128 v[16:19], v6 offset:18432
    v_exp_f32 v76, v76
    v_cvt_pk_bf16_f32 v33, v74, v75
    v_exp_f32 v77, v77
    v_exp_f32 v78, v78
    v_cvt_pk_bf16_f32 v34, v76, v77
    v_exp_f32 v79, v79
    s_waitcnt lgkmcnt(3)
    v_mfma_f32_32x32x16_bf16 v[56:71], v[20:23], v[12:15], v[56:71]
    ds_read_b128 v[20:23], v6 offset:19456
    v_exp_f32 v80, v80
    v_cvt_pk_bf16_f32 v35, v78, v79
    v_exp_f32 v81, v81
    v_exp_f32 v82, v82
    v_cvt_pk_bf16_f32 v36, v80, v81
    v_exp_f32 v83, v83
    s_waitcnt lgkmcnt(3)
    v_mfma_f32_32x32x16_bf16 v[40:55], v[24:27], v[32:35], v[40:55]
    ds_read_b128 v[24:27], v6 offset:23552
    v_exp_f32 v84, v84
    v_cvt_pk_bf16_f32 v37, v82, v83
    v_exp_f32 v85, v85
    v_exp_f32 v86, v86
    v_cvt_pk_bf16_f32 v38, v84, v85
    v_exp_f32 v87, v87
    s_nop 0
    v_cvt_pk_bf16_f32 v39, v86, v87
    s_waitcnt vmcnt(6) lgkmcnt(0)
    s_barrier
    s_add_u32 m0, s49, 16384
    s_add_u32 s50, s48, 100352
    buffer_load_dwordx4 v96, s[44:47], s50 offen lds

    s_add_u32 m0, s49, 24576
    s_add_u32 s50, s48, 150528
    buffer_load_dwordx4 v96, s[44:47], s50 offen lds

    v_cmp_lt_f32 vcc, s22, v52
    s_waitcnt lgkmcnt(3)
    s_nop 1
    s_cbranch_vccnz ATT_rareT4
    v_mfma_f32_32x32x16_bf16 v[40:55], v[28:31], v[36:39], v[40:55]
ATT_backT4:
    ds_read_b128 v[28:31], v6 offset:36864
    v_exp_f32 v56, v56
    v_exp_f32 v57, v57
    v_exp_f32 v58, v58
    v_cvt_pk_bf16_f32 v32, v56, v57
    v_exp_f32 v59, v59
    s_waitcnt lgkmcnt(3)
    v_mfma_f32_32x32x16_bf16 v[72:87], v[16:19], v[8:11], 0
    ds_read_b128 v[16:19], v6 offset:32768
    v_exp_f32 v60, v60
    v_cvt_pk_bf16_f32 v33, v58, v59
    v_exp_f32 v61, v61
    v_exp_f32 v62, v62
    v_cvt_pk_bf16_f32 v34, v60, v61
    v_exp_f32 v63, v63
    s_waitcnt lgkmcnt(3)
    v_mfma_f32_32x32x16_bf16 v[72:87], v[20:23], v[12:15], v[72:87]
    ds_read_b128 v[20:23], v6 offset:33792
    v_exp_f32 v64, v64
    v_cvt_pk_bf16_f32 v35, v62, v63
    v_exp_f32 v65, v65
    v_exp_f32 v66, v66
    v_cvt_pk_bf16_f32 v36, v64, v65
    v_exp_f32 v67, v67
    s_waitcnt lgkmcnt(3)
    v_mfma_f32_32x32x16_bf16 v[40:55], v[24:27], v[32:35], v[40:55]
    ds_read_b128 v[24:27], v6 offset:37888
    v_exp_f32 v68, v68
    v_cvt_pk_bf16_f32 v37, v66, v67
    v_exp_f32 v69, v69
    v_exp_f32 v70, v70
    v_cvt_pk_bf16_f32 v38, v68, v69
    v_exp_f32 v71, v71
    s_nop 0
    v_cvt_pk_bf16_f32 v39, v70, v71
    s_waitcnt lgkmcnt(3)
    s_nop 0
    v_mfma_f32_32x32x16_bf16 v[40:55], v[28:31], v[36:39], v[40:55]
    ds_read_b128 v[28:31], v6 offset:38912
    v_exp_f32 v72, v72
    v_exp_f32 v73, v73
    v_exp_f32 v74, v74
    v_cvt_pk_bf16_f32 v32, v72, v73
    v_exp_f32 v75, v75
    s_waitcnt lgkmcnt(3)
    v_mfma_f32_32x32x16_bf16 v[56:71], v[16:19], v[8:11], 0
    ds_read_b128 v[16:19], v6 offset:34816
    v_exp_f32 v76, v76
    v_cvt_pk_bf16_f32 v33, v74, v75
    v_exp_f32 v77, v77
    v_exp_f32 v78, v78
    v_cvt_pk_bf16_f32 v34, v76, v77
    v_exp_f32 v79, v79
    s_waitcnt lgkmcnt(3)
    v_mfma_f32_32x32x16_bf16 v[56:71], v[20:23], v[12:15], v[56:71]
    ds_read_b128 v[20:23], v6 offset:35840
    v_exp_f32 v80, v80
    v_cvt_pk_bf16_f32 v35, v78, v79
    v_exp_f32 v81, v81
    v_exp_f32 v82, v82
    v_cvt_pk_bf16_f32 v36, v80, v81
    v_exp_f32 v83, v83
    s_waitcnt lgkmcnt(3)
    v_mfma_f32_32x32x16_bf16 v[40:55], v[24:27], v[32:35], v[40:55]
    ds_read_b128 v[24:27], v6 offset:39936
    v_exp_f32 v84, v84
    v_cvt_pk_bf16_f32 v37, v82, v83
    v_exp_f32 v85, v85
    v_exp_f32 v86, v86
    v_cvt_pk_bf16_f32 v38, v84, v85
    v_exp_f32 v87, v87
    s_nop 0
    v_cvt_pk_bf16_f32 v39, v86, v87
    s_waitcnt vmcnt(6) lgkmcnt(0)
    s_barrier
    s_add_u32 m0, s49, 32768
    s_add_u32 s50, s48, 200704
    buffer_load_dwordx4 v96, s[44:47], s50 offen lds

    s_add_u32 m0, s49, 40960
    s_add_u32 s50, s48, 250880
    buffer_load_dwordx4 v96, s[44:47], s50 offen lds

    v_cmp_lt_f32 vcc, s22, v52
    s_waitcnt lgkmcnt(3)
    s_nop 1
    s_cbranch_vccnz ATT_rareT6
    v_mfma_f32_32x32x16_bf16 v[40:55], v[28:31], v[36:39], v[40:55]
ATT_backT6:
    ds_read_b128 v[28:31], v6 offset:53248
    v_exp_f32 v56, v56
    v_exp_f32 v57, v57
    v_exp_f32 v58, v58
    v_cvt_pk_bf16_f32 v32, v56, v57
    v_exp_f32 v59, v59
    s_waitcnt lgkmcnt(3)
    v_mfma_f32_32x32x16_bf16 v[72:87], v[16:19], v[8:11], 0
    ds_read_b128 v[16:19], v6 offset:49152
    v_exp_f32 v60, v60
    v_cvt_pk_bf16_f32 v33, v58, v59
    v_exp_f32 v61, v61
    v_exp_f32 v62, v62
    v_cvt_pk_bf16_f32 v34, v60, v61
    v_exp_f32 v63, v63
    s_waitcnt lgkmcnt(3)
    v_mfma_f32_32x32x16_bf16 v[72:87], v[20:23], v[12:15], v[72:87]
    ds_read_b128 v[20:23], v6 offset:50176
    v_exp_f32 v64, v64
    v_cvt_pk_bf16_f32 v35, v62, v63
    v_exp_f32 v65, v65
    v_exp_f32 v66, v66
    v_cvt_pk_bf16_f32 v36, v64, v65
    v_exp_f32 v67, v67
    s_waitcnt lgkmcnt(3)
    v_mfma_f32_32x32x16_bf16 v[40:55], v[24:27], v[32:35], v[40:55]
    ds_read_b128 v[24:27], v6 offset:54272
    v_exp_f32 v68, v68
    v_cvt_pk_bf16_f32 v37, v66, v67
    v_exp_f32 v69, v69
    v_exp_f32 v70, v70
    v_cvt_pk_bf16_f32 v38, v68, v69
    v_exp_f32 v71, v71
    s_nop 0
    v_cvt_pk_bf16_f32 v39, v70, v71
    s_waitcnt lgkmcnt(3)
    s_nop 0
    v_mfma_f32_32x32x16_bf16 v[40:55], v[28:31], v[36:39], v[40:55]
    ds_read_b128 v[28:31], v6 offset:55296
    v_exp_f32 v72, v72
    v_exp_f32 v73, v73
    v_exp_f32 v74, v74
    v_cvt_pk_bf16_f32 v32, v72, v73
    v_exp_f32 v75, v75
    s_waitcnt lgkmcnt(3)
    v_mfma_f32_32x32x16_bf16 v[56:71], v[16:19], v[8:11], 0
    ds_read_b128 v[16:19], v6 offset:51200
    v_exp_f32 v76, v76
    v_cvt_pk_bf16_f32 v33, v74, v75
    v_exp_f32 v77, v77
    v_exp_f32 v78, v78
    v_cvt_pk_bf16_f32 v34, v76, v77
    v_exp_f32 v79, v79
    s_waitcnt lgkmcnt(3)
    v_mfma_f32_32x32x16_bf16 v[56:71], v[20:23], v[12:15], v[56:71]
    ds_read_b128 v[20:23], v6 offset:52224
    v_exp_f32 v80, v80
    v_cvt_pk_bf16_f32 v35, v78, v79
    v_exp_f32 v81, v81
    v_exp_f32 v82, v82
    v_cvt_pk_bf16_f32 v36, v80, v81
    v_exp_f32 v83, v83
    s_waitcnt lgkmcnt(3)
    v_mfma_f32_32x32x16_bf16 v[40:55], v[24:27], v[32:35], v[40:55]
    ds_read_b128 v[24:27], v6 offset:56320
    v_exp_f32 v84, v84
    v_cvt_pk_bf16_f32 v37, v82, v83
    v_exp_f32 v85, v85
    v_exp_f32 v86, v86
    v_cvt_pk_bf16_f32 v38, v84, v85
    v_exp_f32 v87, v87
    s_nop 0
    v_cvt_pk_bf16_f32 v39, v86, v87
    s_waitcnt lgkmcnt(3)
    s_nop 0
    v_mfma_f32_32x32x16_bf16 v[40:55], v[28:31], v[36:39], v[40:55]
    s_nop 15
    s_mov_b32 s21, 0x7b800000
    s_nop 3
    v_cmp_nle_f32 vcc, v52, s21
    s_and_b64 vcc, vcc, s[30:31]
    s_cbranch_vccnz ATT_safe

ATT_merge:
    s_waitcnt lgkmcnt(0)
    s_barrier
    s_lshl_b32 s21, s14, 12
    s_add_u32 s21, s21, 49152
    v_add_u32 v91, s21, v5
    v_lshrrev_b32 v90, 2, v5
    s_lshl_b32 s21, s14, 8
    s_add_u32 s21, s21, 16384
    v_add_u32 v90, s21, v90
    s_cmp_eq_u32 s13, 0
    s_cbranch_scc1 ATT_lo
    v_cndmask_b32 v53, v53, v88, s[30:31]
    ds_write_b128 v91, v[40:43]
    ds_write_b128 v91, v[44:47] offset:1024
    ds_write_b128 v91, v[48:51] offset:2048
    ds_write_b128 v91, v[52:55] offset:3072

    s_waitcnt lgkmcnt(0)
    s_barrier
    s_branch ATT_end

ATT_lo:
    s_barrier
    ds_read_b128 v[68:71], v91 offset:3072
    ds_read_b128 v[56:59], v91
    ds_read_b128 v[60:63], v91 offset:1024
    ds_read_b128 v[64:67], v91 offset:2048
    s_waitcnt lgkmcnt(3)
    v_mov_b32 v89, v69
    v_mov_b32 v92, v69
    s_nop 1
    v_permlane32_swap_b32 v89, v92
    s_nop 1

    v_max_f32 v89, v88, v92
    v_sub_f32 v90, v88, v89
    v_sub_f32 v91, v92, v89
    v_exp_f32 v90, v90
    v_exp_f32 v91, v91
    s_waitcnt lgkmcnt(0)

    v_mul_f32 v56, v56, v91
    v_mul_f32 v57, v57, v91
    v_mul_f32 v58, v58, v91
    v_mul_f32 v59, v59, v91
    v_mul_f32 v60, v60, v91
    v_mul_f32 v61, v61, v91
    v_mul_f32 v62, v62, v91
    v_mul_f32 v63, v63, v91
    v_mul_f32 v64, v64, v91
    v_mul_f32 v65, v65, v91
    v_mul_f32 v66, v66, v91
    v_mul_f32 v67, v67, v91
    v_mul_f32 v68, v68, v91
    v_mul_f32 v69, v69, v91
    v_mul_f32 v70, v70, v91
    v_mul_f32 v71, v71, v91
    v_fma_f32 v40, v40, v90, v56
    v_fma_f32 v41, v41, v90, v57
    v_fma_f32 v42, v42, v90, v58
    v_fma_f32 v43, v43, v90, v59
    v_fma_f32 v44, v44, v90, v60
    v_fma_f32 v45, v45, v90, v61
    v_fma_f32 v46, v46, v90, v62
    v_fma_f32 v47, v47, v90, v63
    v_fma_f32 v48, v48, v90, v64
    v_fma_f32 v49, v49, v90, v65
    v_fma_f32 v50, v50, v90, v66
    v_fma_f32 v51, v51, v90, v67
    v_fma_f32 v52, v52, v90, v68
    v_fma_f32 v53, v53, v90, v69
    v_fma_f32 v54, v54, v90, v70
    v_fma_f32 v55, v55, v90, v71
    v_mov_b32 v89, v52
    v_mov_b32 v90, v52
    s_nop 1
    v_permlane32_swap_b32 v89, v90
    s_nop 1
    v_rcp_f32 v90, v90
    v_and_b32 v89, 15, v1
    v_lshlrev_b32 v89, 4, v89
    v_lshl_add_u32 v89, v4, 8, v89
    v_bfe_u32 v91, v1, 4, 1
    v_lshl_add_u32 v89, v91, 14, v89

    v_mul_f32 v40, v40, v90
    v_mul_f32 v41, v41, v90
    v_mul_f32 v42, v42, v90
    v_mul_f32 v43, v43, v90
    v_mul_f32 v44, v44, v90
    v_mul_f32 v45, v45, v90
    v_mul_f32 v46, v46, v90
    v_mul_f32 v47, v47, v90
    v_mul_f32 v48, v48, v90
    v_mul_f32 v49, v49, v90
    v_mul_f32 v50, v50, v90
    v_mul_f32 v51, v51, v90
    v_mul_f32 v52, v52, v90
    v_mul_f32 v53, v53, v90
    v_mul_f32 v54, v54, v90
    v_mul_f32 v55, v55, v90
    v_cndmask_b32 v52, v52, 0, s[30:31]
    v_cndmask_b32 v53, v53, 0, s[30:31]
    v_cndmask_b32 v54, v54, 0, s[30:31]
    v_cndmask_b32 v55, v55, 0, s[30:31]
    v_cvt_pk_bf16_f32 v32, v40, v41
    v_cvt_pk_bf16_f32 v33, v42, v43
    v_cvt_pk_bf16_f32 v34, v44, v45
    v_cvt_pk_bf16_f32 v35, v46, v47
    v_cvt_pk_bf16_f32 v36, v48, v49
    v_cvt_pk_bf16_f32 v37, v50, v51
    v_cvt_pk_bf16_f32 v38, v52, v53
    v_cvt_pk_bf16_f32 v39, v54, v55
    s_lshl_b32 s21, s12, 2
    s_add_u32 s21, s21, s14
    s_lshl_b32 s21, s21, 15
    s_lshl_b32 s20, s11, 10
    s_add_u32 s21, s21, s20
    s_add_u32 s21, s21, 6291456
    buffer_store_dwordx4 v[32:35], v89, s[24:27], s21 offen sc1
    buffer_store_dwordx4 v[36:39], v89, s[24:27], s21 offen offset:512 sc1
    s_branch ATT_end

ATT_rareL0:
    v_mfma_f32_32x32x16_bf16 v[40:55], v[28:31], v[36:39], v[40:55]
    s_nop 15
    v_mov_b32 v89, v52
    v_mov_b32 v90, v52
    s_nop 1
    v_permlane32_swap_b32 v89, v90
    s_nop 1
    v_frexp_exp_i32_f32 v89, v90
    v_med3_i32 v89, v89, 0, 64
    v_cvt_f32_i32 v89, v89
    v_add_f32 v89, v88, v89
    v_cvt_pk_bf16_f32 v90, v89, v89
    v_and_b32 v91, 0xffff0000, v90
    v_sub_f32 v92, v91, v88
    v_mov_b32 v88, v91
    v_lshrrev_b32 v90, 16, v91
    v_xor_b32 v90, 0x8000, v90
    v_cndmask_b32 v14, v14, v90, s[30:31]
    v_sub_f32 v89, 0, v92
    v_exp_f32 v89, v89

    v_sub_f32 v56, v56, v92
    v_sub_f32 v57, v57, v92
    v_sub_f32 v58, v58, v92
    v_sub_f32 v59, v59, v92
    v_sub_f32 v60, v60, v92
    v_sub_f32 v61, v61, v92
    v_sub_f32 v62, v62, v92
    v_sub_f32 v63, v63, v92
    v_sub_f32 v64, v64, v92
    v_sub_f32 v65, v65, v92
    v_sub_f32 v66, v66, v92
    v_sub_f32 v67, v67, v92
    v_sub_f32 v68, v68, v92
    v_sub_f32 v69, v69, v92
    v_sub_f32 v70, v70, v92
    v_sub_f32 v71, v71, v92
    v_mul_f32 v40, v40, v89
    v_mul_f32 v41, v41, v89
    v_mul_f32 v42, v42, v89
    v_mul_f32 v43, v43, v89
    v_mul_f32 v44, v44, v89
    v_mul_f32 v45, v45, v89
    v_mul_f32 v46, v46, v89
    v_mul_f32 v47, v47, v89
    v_mul_f32 v48, v48, v89
    v_mul_f32 v49, v49, v89
    v_mul_f32 v50, v50, v89
    v_mul_f32 v51, v51, v89
    v_mul_f32 v52, v52, v89
    v_mul_f32 v53, v53, v89
    v_mul_f32 v54, v54, v89
    v_mul_f32 v55, v55, v89
    s_nop 1
    s_branch ATT_backL0

ATT_rareL2:
    v_mfma_f32_32x32x16_bf16 v[40:55], v[28:31], v[36:39], v[40:55]
    s_nop 15
    v_mov_b32 v89, v52
    v_mov_b32 v90, v52
    s_nop 1
    v_permlane32_swap_b32 v89, v90
    s_nop 1
    v_frexp_exp_i32_f32 v89, v90
    v_med3_i32 v89, v89, 0, 64
    v_cvt_f32_i32 v89, v89
    v_add_f32 v89, v88, v89
    v_cvt_pk_bf16_f32 v90, v89, v89
    v_and_b32 v91, 0xffff0000, v90
    v_sub_f32 v92, v91, v88
    v_mov_b32 v88, v91
    v_lshrrev_b32 v90, 16, v91
    v_xor_b32 v90, 0x8000, v90
    v_cndmask_b32 v14, v14, v90, s[30:31]
    v_sub_f32 v89, 0, v92
    v_exp_f32 v89, v89

    v_sub_f32 v56, v56, v92
    v_sub_f32 v57, v57, v92
    v_sub_f32 v58, v58, v92
    v_sub_f32 v59, v59, v92
    v_sub_f32 v60, v60, v92
    v_sub_f32 v61, v61, v92
    v_sub_f32 v62, v62, v92
    v_sub_f32 v63, v63, v92
    v_sub_f32 v64, v64, v92
    v_sub_f32 v65, v65, v92
    v_sub_f32 v66, v66, v92
    v_sub_f32 v67, v67, v92
    v_sub_f32 v68, v68, v92
    v_sub_f32 v69, v69, v92
    v_sub_f32 v70, v70, v92
    v_sub_f32 v71, v71, v92
    v_mul_f32 v40, v40, v89
    v_mul_f32 v41, v41, v89
    v_mul_f32 v42, v42, v89
    v_mul_f32 v43, v43, v89
    v_mul_f32 v44, v44, v89
    v_mul_f32 v45, v45, v89
    v_mul_f32 v46, v46, v89
    v_mul_f32 v47, v47, v89
    v_mul_f32 v48, v48, v89
    v_mul_f32 v49, v49, v89
    v_mul_f32 v50, v50, v89
    v_mul_f32 v51, v51, v89
    v_mul_f32 v52, v52, v89
    v_mul_f32 v53, v53, v89
    v_mul_f32 v54, v54, v89
    v_mul_f32 v55, v55, v89
    s_nop 1
    s_branch ATT_backL2

ATT_rareL4:
    v_mfma_f32_32x32x16_bf16 v[40:55], v[28:31], v[36:39], v[40:55]
    s_nop 15
    v_mov_b32 v89, v52
    v_mov_b32 v90, v52
    s_nop 1
    v_permlane32_swap_b32 v89, v90
    s_nop 1
    v_frexp_exp_i32_f32 v89, v90
    v_med3_i32 v89, v89, 0, 64
    v_cvt_f32_i32 v89, v89
    v_add_f32 v89, v88, v89
    v_cvt_pk_bf16_f32 v90, v89, v89
    v_and_b32 v91, 0xffff0000, v90
    v_sub_f32 v92, v91, v88
    v_mov_b32 v88, v91
    v_lshrrev_b32 v90, 16, v91
    v_xor_b32 v90, 0x8000, v90
    v_cndmask_b32 v14, v14, v90, s[30:31]
    v_sub_f32 v89, 0, v92
    v_exp_f32 v89, v89

    v_sub_f32 v56, v56, v92
    v_sub_f32 v57, v57, v92
    v_sub_f32 v58, v58, v92
    v_sub_f32 v59, v59, v92
    v_sub_f32 v60, v60, v92
    v_sub_f32 v61, v61, v92
    v_sub_f32 v62, v62, v92
    v_sub_f32 v63, v63, v92
    v_sub_f32 v64, v64, v92
    v_sub_f32 v65, v65, v92
    v_sub_f32 v66, v66, v92
    v_sub_f32 v67, v67, v92
    v_sub_f32 v68, v68, v92
    v_sub_f32 v69, v69, v92
    v_sub_f32 v70, v70, v92
    v_sub_f32 v71, v71, v92
    v_mul_f32 v40, v40, v89
    v_mul_f32 v41, v41, v89
    v_mul_f32 v42, v42, v89
    v_mul_f32 v43, v43, v89
    v_mul_f32 v44, v44, v89
    v_mul_f32 v45, v45, v89
    v_mul_f32 v46, v46, v89
    v_mul_f32 v47, v47, v89
    v_mul_f32 v48, v48, v89
    v_mul_f32 v49, v49, v89
    v_mul_f32 v50, v50, v89
    v_mul_f32 v51, v51, v89
    v_mul_f32 v52, v52, v89
    v_mul_f32 v53, v53, v89
    v_mul_f32 v54, v54, v89
    v_mul_f32 v55, v55, v89
    s_nop 1
    s_branch ATT_backL4

ATT_rareL6:
    v_mfma_f32_32x32x16_bf16 v[40:55], v[28:31], v[36:39], v[40:55]
    s_nop 15
    v_mov_b32 v89, v52
    v_mov_b32 v90, v52
    s_nop 1
    v_permlane32_swap_b32 v89, v90
    s_nop 1
    v_frexp_exp_i32_f32 v89, v90
    v_med3_i32 v89, v89, 0, 64
    v_cvt_f32_i32 v89, v89
    v_add_f32 v89, v88, v89
    v_cvt_pk_bf16_f32 v90, v89, v89
    v_and_b32 v91, 0xffff0000, v90
    v_sub_f32 v92, v91, v88
    v_mov_b32 v88, v91
    v_lshrrev_b32 v90, 16, v91
    v_xor_b32 v90, 0x8000, v90
    v_cndmask_b32 v14, v14, v90, s[30:31]
    v_sub_f32 v89, 0, v92
    v_exp_f32 v89, v89

    v_sub_f32 v56, v56, v92
    v_sub_f32 v57, v57, v92
    v_sub_f32 v58, v58, v92
    v_sub_f32 v59, v59, v92
    v_sub_f32 v60, v60, v92
    v_sub_f32 v61, v61, v92
    v_sub_f32 v62, v62, v92
    v_sub_f32 v63, v63, v92
    v_sub_f32 v64, v64, v92
    v_sub_f32 v65, v65, v92
    v_sub_f32 v66, v66, v92
    v_sub_f32 v67, v67, v92
    v_sub_f32 v68, v68, v92
    v_sub_f32 v69, v69, v92
    v_sub_f32 v70, v70, v92
    v_sub_f32 v71, v71, v92
    v_mul_f32 v40, v40, v89
    v_mul_f32 v41, v41, v89
    v_mul_f32 v42, v42, v89
    v_mul_f32 v43, v43, v89
    v_mul_f32 v44, v44, v89
    v_mul_f32 v45, v45, v89
    v_mul_f32 v46, v46, v89
    v_mul_f32 v47, v47, v89
    v_mul_f32 v48, v48, v89
    v_mul_f32 v49, v49, v89
    v_mul_f32 v50, v50, v89
    v_mul_f32 v51, v51, v89
    v_mul_f32 v52, v52, v89
    v_mul_f32 v53, v53, v89
    v_mul_f32 v54, v54, v89
    v_mul_f32 v55, v55, v89
    s_nop 1
    s_branch ATT_backL6

ATT_rareT0:
    v_mfma_f32_32x32x16_bf16 v[40:55], v[28:31], v[36:39], v[40:55]
    s_nop 15
    v_mov_b32 v89, v52
    v_mov_b32 v90, v52
    s_nop 1
    v_permlane32_swap_b32 v89, v90
    s_nop 1
    v_frexp_exp_i32_f32 v89, v90
    v_med3_i32 v89, v89, 0, 64
    v_cvt_f32_i32 v89, v89
    v_add_f32 v89, v88, v89
    v_cvt_pk_bf16_f32 v90, v89, v89
    v_and_b32 v91, 0xffff0000, v90
    v_sub_f32 v92, v91, v88
    v_mov_b32 v88, v91
    v_lshrrev_b32 v90, 16, v91
    v_xor_b32 v90, 0x8000, v90
    v_cndmask_b32 v14, v14, v90, s[30:31]
    v_sub_f32 v89, 0, v92
    v_exp_f32 v89, v89

    v_sub_f32 v56, v56, v92
    v_sub_f32 v57, v57, v92
    v_sub_f32 v58, v58, v92
    v_sub_f32 v59, v59, v92
    v_sub_f32 v60, v60, v92
    v_sub_f32 v61, v61, v92
    v_sub_f32 v62, v62, v92
    v_sub_f32 v63, v63, v92
    v_sub_f32 v64, v64, v92
    v_sub_f32 v65, v65, v92
    v_sub_f32 v66, v66, v92
    v_sub_f32 v67, v67, v92
    v_sub_f32 v68, v68, v92
    v_sub_f32 v69, v69, v92
    v_sub_f32 v70, v70, v92
    v_sub_f32 v71, v71, v92
    v_mul_f32 v40, v40, v89
    v_mul_f32 v41, v41, v89
    v_mul_f32 v42, v42, v89
    v_mul_f32 v43, v43, v89
    v_mul_f32 v44, v44, v89
    v_mul_f32 v45, v45, v89
    v_mul_f32 v46, v46, v89
    v_mul_f32 v47, v47, v89
    v_mul_f32 v48, v48, v89
    v_mul_f32 v49, v49, v89
    v_mul_f32 v50, v50, v89
    v_mul_f32 v51, v51, v89
    v_mul_f32 v52, v52, v89
    v_mul_f32 v53, v53, v89
    v_mul_f32 v54, v54, v89
    v_mul_f32 v55, v55, v89
    s_nop 1
    s_branch ATT_backT0

ATT_rareT2:
    v_mfma_f32_32x32x16_bf16 v[40:55], v[28:31], v[36:39], v[40:55]
    s_nop 15
    v_mov_b32 v89, v52
    v_mov_b32 v90, v52
    s_nop 1
    v_permlane32_swap_b32 v89, v90
    s_nop 1
    v_frexp_exp_i32_f32 v89, v90
    v_med3_i32 v89, v89, 0, 64
    v_cvt_f32_i32 v89, v89
    v_add_f32 v89, v88, v89
    v_cvt_pk_bf16_f32 v90, v89, v89
    v_and_b32 v91, 0xffff0000, v90
    v_sub_f32 v92, v91, v88
    v_mov_b32 v88, v91
    v_lshrrev_b32 v90, 16, v91
    v_xor_b32 v90, 0x8000, v90
    v_cndmask_b32 v14, v14, v90, s[30:31]
    v_sub_f32 v89, 0, v92
    v_exp_f32 v89, v89

    v_sub_f32 v56, v56, v92
    v_sub_f32 v57, v57, v92
    v_sub_f32 v58, v58, v92
    v_sub_f32 v59, v59, v92
    v_sub_f32 v60, v60, v92
    v_sub_f32 v61, v61, v92
    v_sub_f32 v62, v62, v92
    v_sub_f32 v63, v63, v92
    v_sub_f32 v64, v64, v92
    v_sub_f32 v65, v65, v92
    v_sub_f32 v66, v66, v92
    v_sub_f32 v67, v67, v92
    v_sub_f32 v68, v68, v92
    v_sub_f32 v69, v69, v92
    v_sub_f32 v70, v70, v92
    v_sub_f32 v71, v71, v92
    v_mul_f32 v40, v40, v89
    v_mul_f32 v41, v41, v89
    v_mul_f32 v42, v42, v89
    v_mul_f32 v43, v43, v89
    v_mul_f32 v44, v44, v89
    v_mul_f32 v45, v45, v89
    v_mul_f32 v46, v46, v89
    v_mul_f32 v47, v47, v89
    v_mul_f32 v48, v48, v89
    v_mul_f32 v49, v49, v89
    v_mul_f32 v50, v50, v89
    v_mul_f32 v51, v51, v89
    v_mul_f32 v52, v52, v89
    v_mul_f32 v53, v53, v89
    v_mul_f32 v54, v54, v89
    v_mul_f32 v55, v55, v89
    s_nop 1
    s_branch ATT_backT2

ATT_rareT4:
    v_mfma_f32_32x32x16_bf16 v[40:55], v[28:31], v[36:39], v[40:55]
    s_nop 15
    v_mov_b32 v89, v52
    v_mov_b32 v90, v52
    s_nop 1
    v_permlane32_swap_b32 v89, v90
    s_nop 1
    v_frexp_exp_i32_f32 v89, v90
    v_med3_i32 v89, v89, 0, 64
    v_cvt_f32_i32 v89, v89
    v_add_f32 v89, v88, v89
    v_cvt_pk_bf16_f32 v90, v89, v89
    v_and_b32 v91, 0xffff0000, v90
    v_sub_f32 v92, v91, v88
    v_mov_b32 v88, v91
    v_lshrrev_b32 v90, 16, v91
    v_xor_b32 v90, 0x8000, v90
    v_cndmask_b32 v14, v14, v90, s[30:31]
    v_sub_f32 v89, 0, v92
    v_exp_f32 v89, v89

    v_sub_f32 v56, v56, v92
    v_sub_f32 v57, v57, v92
    v_sub_f32 v58, v58, v92
    v_sub_f32 v59, v59, v92
    v_sub_f32 v60, v60, v92
    v_sub_f32 v61, v61, v92
    v_sub_f32 v62, v62, v92
    v_sub_f32 v63, v63, v92
    v_sub_f32 v64, v64, v92
    v_sub_f32 v65, v65, v92
    v_sub_f32 v66, v66, v92
    v_sub_f32 v67, v67, v92
    v_sub_f32 v68, v68, v92
    v_sub_f32 v69, v69, v92
    v_sub_f32 v70, v70, v92
    v_sub_f32 v71, v71, v92
    v_mul_f32 v40, v40, v89
    v_mul_f32 v41, v41, v89
    v_mul_f32 v42, v42, v89
    v_mul_f32 v43, v43, v89
    v_mul_f32 v44, v44, v89
    v_mul_f32 v45, v45, v89
    v_mul_f32 v46, v46, v89
    v_mul_f32 v47, v47, v89
    v_mul_f32 v48, v48, v89
    v_mul_f32 v49, v49, v89
    v_mul_f32 v50, v50, v89
    v_mul_f32 v51, v51, v89
    v_mul_f32 v52, v52, v89
    v_mul_f32 v53, v53, v89
    v_mul_f32 v54, v54, v89
    v_mul_f32 v55, v55, v89
    s_nop 1
    s_branch ATT_backT4

ATT_rareT6:
    v_mfma_f32_32x32x16_bf16 v[40:55], v[28:31], v[36:39], v[40:55]
    s_nop 15
    v_mov_b32 v89, v52
    v_mov_b32 v90, v52
    s_nop 1
    v_permlane32_swap_b32 v89, v90
    s_nop 1
    v_frexp_exp_i32_f32 v89, v90
    v_med3_i32 v89, v89, 0, 64
    v_cvt_f32_i32 v89, v89
    v_add_f32 v89, v88, v89
    v_cvt_pk_bf16_f32 v90, v89, v89
    v_and_b32 v91, 0xffff0000, v90
    v_sub_f32 v92, v91, v88
    v_mov_b32 v88, v91
    v_lshrrev_b32 v90, 16, v91
    v_xor_b32 v90, 0x8000, v90
    v_cndmask_b32 v14, v14, v90, s[30:31]
    v_sub_f32 v89, 0, v92
    v_exp_f32 v89, v89

    v_sub_f32 v56, v56, v92
    v_sub_f32 v57, v57, v92
    v_sub_f32 v58, v58, v92
    v_sub_f32 v59, v59, v92
    v_sub_f32 v60, v60, v92
    v_sub_f32 v61, v61, v92
    v_sub_f32 v62, v62, v92
    v_sub_f32 v63, v63, v92
    v_sub_f32 v64, v64, v92
    v_sub_f32 v65, v65, v92
    v_sub_f32 v66, v66, v92
    v_sub_f32 v67, v67, v92
    v_sub_f32 v68, v68, v92
    v_sub_f32 v69, v69, v92
    v_sub_f32 v70, v70, v92
    v_sub_f32 v71, v71, v92
    v_mul_f32 v40, v40, v89
    v_mul_f32 v41, v41, v89
    v_mul_f32 v42, v42, v89
    v_mul_f32 v43, v43, v89
    v_mul_f32 v44, v44, v89
    v_mul_f32 v45, v45, v89
    v_mul_f32 v46, v46, v89
    v_mul_f32 v47, v47, v89
    v_mul_f32 v48, v48, v89
    v_mul_f32 v49, v49, v89
    v_mul_f32 v50, v50, v89
    v_mul_f32 v51, v51, v89
    v_mul_f32 v52, v52, v89
    v_mul_f32 v53, v53, v89
    v_mul_f32 v54, v54, v89
    v_mul_f32 v55, v55, v89
    s_nop 1
    s_branch ATT_backT6

ATT_safe:
    s_waitcnt lgkmcnt(0)
    v_cndmask_b32 v14, v14, 0, s[30:31]
    v_mov_b32 v88, 0xff7fffff
    s_mov_b32 s23, 0

    v_mov_b32 v40, 0
    v_mov_b32 v41, 0
    v_mov_b32 v42, 0
    v_mov_b32 v43, 0
    v_mov_b32 v44, 0
    v_mov_b32 v45, 0
    v_mov_b32 v46, 0
    v_mov_b32 v47, 0
    v_mov_b32 v48, 0
    v_mov_b32 v49, 0
    v_mov_b32 v50, 0
    v_mov_b32 v51, 0
    v_mov_b32 v52, 0
    v_mov_b32 v53, 0
    v_mov_b32 v54, 0
    v_mov_b32 v55, 0
ATT_safe_loop:
    buffer_load_dwordx4 v[16:19], v5, s[24:27], s32 offen
    buffer_load_dwordx4 v[20:23], v5, s[24:27], s32 offen offset:1024
    buffer_load_dwordx4 v[24:27], v5, s[24:27], s33 offen
    buffer_load_dwordx4 v[28:31], v5, s[24:27], s33 offen offset:1024
    s_add_u32 s32, s32, 2048
    s_add_u32 s33, s33, 2048
    s_waitcnt vmcnt(0)
    v_mfma_f32_32x32x16_bf16 v[56:71], v[16:19], v[8:11], 0
    v_mfma_f32_32x32x16_bf16 v[56:71], v[20:23], v[12:15], v[56:71]
    s_nop 15
    v_max3_f32 v89, v56, v57, v58
    v_max3_f32 v90, v59, v60, v61
    v_max3_f32 v89, v89, v62, v63
    v_max3_f32 v90, v90, v64, v65
    v_max3_f32 v89, v89, v66, v67
    v_max3_f32 v90, v90, v68, v69
    v_max3_f32 v89, v89, v70, v71
    v_max3_f32 v89, v89, v90, v88
    v_mov_b32 v90, v89
    s_nop 1
    v_permlane32_swap_b32 v89, v90
    s_nop 1
    v_max_f32 v89, v89, v90
    v_sub_f32 v90, v88, v89
    v_exp_f32 v90, v90
    v_mov_b32 v88, v89

    v_sub_f32 v56, v56, v88
    v_sub_f32 v57, v57, v88
    v_sub_f32 v58, v58, v88
    v_sub_f32 v59, v59, v88
    v_sub_f32 v60, v60, v88
    v_sub_f32 v61, v61, v88
    v_sub_f32 v62, v62, v88
    v_sub_f32 v63, v63, v88
    v_sub_f32 v64, v64, v88
    v_sub_f32 v65, v65, v88
    v_sub_f32 v66, v66, v88
    v_sub_f32 v67, v67, v88
    v_sub_f32 v68, v68, v88
    v_sub_f32 v69, v69, v88
    v_sub_f32 v70, v70, v88
    v_sub_f32 v71, v71, v88
    v_exp_f32 v56, v56
    v_exp_f32 v57, v57
    v_exp_f32 v58, v58
    v_exp_f32 v59, v59
    v_exp_f32 v60, v60
    v_exp_f32 v61, v61
    v_exp_f32 v62, v62
    v_exp_f32 v63, v63
    v_exp_f32 v64, v64
    v_exp_f32 v65, v65
    v_exp_f32 v66, v66
    v_exp_f32 v67, v67
    v_exp_f32 v68, v68
    v_exp_f32 v69, v69
    v_exp_f32 v70, v70
    v_exp_f32 v71, v71
    v_mul_f32 v40, v40, v90
    v_mul_f32 v41, v41, v90
    v_mul_f32 v42, v42, v90
    v_mul_f32 v43, v43, v90
    v_mul_f32 v44, v44, v90
    v_mul_f32 v45, v45, v90
    v_mul_f32 v46, v46, v90
    v_mul_f32 v47, v47, v90
    v_mul_f32 v48, v48, v90
    v_mul_f32 v49, v49, v90
    v_mul_f32 v50, v50, v90
    v_mul_f32 v51, v51, v90
    v_mul_f32 v52, v52, v90
    v_mul_f32 v53, v53, v90
    v_mul_f32 v54, v54, v90
    v_mul_f32 v55, v55, v90
    v_cvt_pk_bf16_f32 v32, v56, v57
    v_cvt_pk_bf16_f32 v33, v58, v59
    v_cvt_pk_bf16_f32 v34, v60, v61
    v_cvt_pk_bf16_f32 v35, v62, v63
    v_cvt_pk_bf16_f32 v36, v64, v65
    v_cvt_pk_bf16_f32 v37, v66, v67
    v_cvt_pk_bf16_f32 v38, v68, v69
    v_cvt_pk_bf16_f32 v39, v70, v71
    s_nop 1
    v_mfma_f32_32x32x16_bf16 v[40:55], v[24:27], v[32:35], v[40:55]
    v_mfma_f32_32x32x16_bf16 v[40:55], v[28:31], v[36:39], v[40:55]
    s_nop 15
    s_add_u32 s23, s23, 1
    s_cmp_lt_u32 s23, 32
    s_cbranch_scc1 ATT_safe_loop
    s_branch ATT_merge

ATT_end:
    s_memrealtime s[90:91]
    s_lshl_b32 s86, s3, 7
    s_add_u32 s86, s86, 16809984
    v_mov_b32 v4, 0
    s_waitcnt vmcnt(0) lgkmcnt(0)
    v_mov_b32 v2, s90
    v_mov_b32 v3, s91
    s_barrier
    s_cmp_lg_u32 s10, 7
    s_cbranch_scc1 SIG_skip3
    s_mov_b64 exec, 1
    buffer_store_dwordx2 v[2:3], v4, s[24:27], s86 offen sc1
    s_mov_b64 exec, -1

SIG_skip3:
    s_cmp_lg_u32 s83, 0
    s_cbranch_scc1 HELP_NEXT

A_OUT:
    s_cmp_ge_u32 s82, 224
    s_cbranch_scc1 M_done
    s_mov_b32 s2, s82

    s_mov_b32 s3, s2
    s_and_b32 s11, s2, 31
    s_lshr_b32 s12, s2, 5
    s_and_b32 s44, s10, 3
    s_lshr_b32 s45, s10, 2
    v_lshrrev_b32 v8, 3, v1
    v_mul_u32_u24 v8, 896, v8
    v_and_b32 v9, 7, v1
    v_bfe_u32 v10, v1, 4, 1
    v_lshlrev_b32 v10, 1, v10
    v_xor_b32 v9, v9, v10
    s_and_b32 s15, s10, 1
    s_lshl_b32 s15, s15, 2
    v_xor_b32 v9, s15, v9
    v_lshl_add_u32 v8, v9, 4, v8
    s_mul_i32 s15, s44, 7168
    s_lshl_b32 s29, s12, 7
    s_add_u32 s15, s15, s29
    s_mul_i32 s29, s45, 25088
    s_add_u32 s15, s15, s29
    s_lshl_b32 s28, s44, 10
    s_lshl_b32 s29, s45, 12
    s_add_u32 s28, s28, s29
    s_lshl_b32 s13, s11, 2
    s_add_u32 s13, s13, s44
    s_lshl_b32 s13, s13, 14
    s_lshl_b32 s29, s45, 13
    s_add_u32 s13, s13, s29
    s_add_u32 s13, s13, 6291456

    s_mov_b32 s32, s80
    s_mov_b32 s33, s81
    s_mov_b32 s34, 0x380000
    s_mov_b32 s35, 0x00020000
    s_mov_b32 s16, s68
    s_mov_b32 s17, s69
    s_mov_b32 s18, 0x62000
    s_mov_b32 s19, 0x00020000
    s_cmp_lg_u32 s83, 4
    s_cbranch_scc1 OUT_nodma

    s_add_u32 m0, s28, 0
    s_add_u32 s29, s15, 0
    buffer_load_dwordx4 v8, s[16:19], s29 offen lds

    s_add_u32 m0, s28, 8192
    s_add_u32 s29, s15, 50176
    buffer_load_dwordx4 v8, s[16:19], s29 offen lds

    s_add_u32 m0, s28, 16384
    s_add_u32 s29, s15, 100352
    buffer_load_dwordx4 v8, s[16:19], s29 offen lds

    s_add_u32 m0, s28, 24576
    s_add_u32 s29, s15, 150528
    buffer_load_dwordx4 v8, s[16:19], s29 offen lds

    s_add_u32 m0, s28, 32768
    s_add_u32 s29, s15, 200704
    buffer_load_dwordx4 v8, s[16:19], s29 offen lds

    s_add_u32 m0, s28, 40960
    s_add_u32 s29, s15, 250880
    buffer_load_dwordx4 v8, s[16:19], s29 offen lds

    s_add_u32 m0, s28, 65536
    s_add_u32 s29, s15, 301056
    buffer_load_dwordx4 v8, s[16:19], s29 offen lds

    s_add_u32 m0, s28, 73728
    s_add_u32 s29, s15, 351232
    buffer_load_dwordx4 v8, s[16:19], s29 offen lds

OUT_nodma:
    v_and_b32 v3, 15, v1
    v_lshrrev_b32 v4, 4, v1
    v_lshrrev_b32 v9, 2, v3
    v_lshl_add_u32 v9, v4, 3, v9
    v_lshlrev_b32 v9, 7, v9
    v_and_b32 v10, 3, v3
    v_lshl_add_u32 v9, v10, 3, v9
    v_lshrrev_b32 v10, 3, v3
    v_and_b32 v11, 1, v4
    v_lshl_add_u32 v10, v11, 1, v10
    v_lshl_add_u32 v12, v10, 5, v9
    s_lshl_b32 s29, s45, 15
    v_add_u32 v12, s29, v12
    v_xor_b32 v13, 32, v12
    v_xor_b32 v14, 64, v12
    v_xor_b32 v15, 96, v12
    s_lshl_b32 s15, s11, 6
    s_lshl_b32 s29, s44, 4
    s_add_u32 s15, s15, s29
    s_mul_i32 s15, s15, 1792
    s_lshl_b32 s14, s12, 7
    s_add_u32 s15, s15, s14
    s_lshl_b32 s14, s45, 6
    s_add_u32 s15, s15, s14
    v_mul_u32_u24 v7, 1792, v3
    v_and_b32 v11, 1, v4
    v_lshl_add_u32 v7, v11, 5, v7
    v_lshrrev_b32 v11, 1, v4
    v_lshl_add_u32 v7, v11, 4, v7
    s_xor_b32 s29, s10, 4
    s_lshl_b32 s29, s29, 11
    v_add_u32 v10, s29, v5
    s_lshl_b32 s29, s10, 11
    v_add_u32 v11, s29, v5

    v_mov_b32 v0, v7
    s_waitcnt vmcnt(0)
    s_barrier

    ds_read_b64_tr_b16 v[32:33], v12 offset:0
    ds_read_b64_tr_b16 v[34:35], v12 offset:512
    ds_read_b64_tr_b16 v[36:37], v13 offset:0
    ds_read_b64_tr_b16 v[38:39], v13 offset:512
    ds_read_b64_tr_b16 v[40:41], v14 offset:0
    ds_read_b64_tr_b16 v[42:43], v14 offset:512
    ds_read_b64_tr_b16 v[44:45], v15 offset:0
    ds_read_b64_tr_b16 v[46:47], v15 offset:512
    s_waitcnt lgkmcnt(7)
    ds_read_b64_tr_b16 v[48:49], v12 offset:4096
    ds_read_b64_tr_b16 v[50:51], v12 offset:4608
    ds_read_b64_tr_b16 v[52:53], v13 offset:4096
    ds_read_b64_tr_b16 v[54:55], v13 offset:4608
    ds_read_b64_tr_b16 v[56:57], v14 offset:4096
    ds_read_b64_tr_b16 v[58:59], v14 offset:4608
    ds_read_b64_tr_b16 v[60:61], v15 offset:4096
    ds_read_b64_tr_b16 v[62:63], v15 offset:4608
    s_waitcnt lgkmcnt(7)
    ds_read_b64_tr_b16 v[64:65], v12 offset:8192
    ds_read_b64_tr_b16 v[66:67], v12 offset:8704
    ds_read_b64_tr_b16 v[68:69], v13 offset:8192
    ds_read_b64_tr_b16 v[70:71], v13 offset:8704
    ds_read_b64_tr_b16 v[72:73], v14 offset:8192
    ds_read_b64_tr_b16 v[74:75], v14 offset:8704
    ds_read_b64_tr_b16 v[76:77], v15 offset:8192
    ds_read_b64_tr_b16 v[78:79], v15 offset:8704
    s_waitcnt lgkmcnt(7)
    ds_read_b64_tr_b16 v[80:81], v12 offset:12288
    ds_read_b64_tr_b16 v[82:83], v12 offset:12800
    ds_read_b64_tr_b16 v[84:85], v13 offset:12288
    ds_read_b64_tr_b16 v[86:87], v13 offset:12800
    ds_read_b64_tr_b16 v[88:89], v14 offset:12288
    ds_read_b64_tr_b16 v[90:91], v14 offset:12800
    ds_read_b64_tr_b16 v[92:93], v15 offset:12288
    ds_read_b64_tr_b16 v[94:95], v15 offset:12800
    s_lshr_b32 s29, s11, 1
    s_lshl_b32 s29, s29, 11
    s_add_u32 s29, s29, 16809984
    v_and_b32 v3, 15, v1
    v_lshlrev_b32 v3, 7, v3
    v_add_u32 v3, s29, v3

    s_sleep 8
    s_cmp_ge_u32 s10, 4
    s_cbranch_scc1 W_oth4
    s_lshl_b32 s91, s10, 2
    s_add_u32 s91, s91, 49152
    v_mov_b32 v2, s91
    s_mov_b32 s90, 0
    v_mov_b32 v4, 0
    s_cmp_ge_u32 s10, 1
    s_cbranch_scc1 W_ok4
    s_cmp_eq_u32 s83, 4
    s_cbranch_scc1 W_ok4
    v_mov_b32 v4, s85

W_spin4:
    buffer_load_dwordx2 v[6:7], v3, s[24:27], 0 offen sc1
    s_add_u32 s90, s90, 1
    s_waitcnt vmcnt(0)
    v_subrev_co_u32 v6, vcc, s84, v6
    v_subb_co_u32 v7, vcc, v7, v4, vcc
    v_lshrrev_b32 v6, 24, v6
    v_or_b32 v6, v6, v7
    v_cmpx_ne_u32 vcc, 0, v6
    s_nop 1
    s_cbranch_execz W_pass4
    s_sleep 6
    s_cmp_lt_u32 s90, 20000
    s_cbranch_scc1 W_spin4
    s_mov_b64 exec, -1
    v_mov_b32 v4, 1
    s_branch W_ok4

W_pass4:
    s_mov_b64 exec, -1
    v_mov_b32 v4, 0

W_ok4:
    s_mov_b64 exec, 1
    ds_write_b32 v2, v4
    s_mov_b64 exec, -1
    s_waitcnt lgkmcnt(0)

W_oth4:
    v_mov_b32 v2, 49152
    s_waitcnt vmcnt(0)
    s_barrier
    ds_read_b128 v[6:9], v2
    s_mov_b32 s83, 0
    s_waitcnt lgkmcnt(0)
    v_or3_b32 v6, v6, v7, v8
    v_or_b32 v6, v6, v9
    s_nop 0
    v_readfirstlane_b32 s91, v6
    s_cmp_lg_u32 s91, 0
    s_cbranch_scc1 HELP2

    buffer_load_dwordx4 v[96:99], v5, s[24:27], s13 offen offset:0
    buffer_load_dwordx4 v[100:103], v5, s[24:27], s13 offen offset:1024
    buffer_load_dwordx4 v[104:107], v5, s[24:27], s13 offen offset:2048
    buffer_load_dwordx4 v[108:111], v5, s[24:27], s13 offen offset:3072
    s_add_u32 s13, s13, 4096
    buffer_load_dwordx4 v[112:115], v5, s[24:27], s13 offen offset:0
    buffer_load_dwordx4 v[116:119], v5, s[24:27], s13 offen offset:1024
    buffer_load_dwordx4 v[120:123], v5, s[24:27], s13 offen offset:2048
    buffer_load_dwordx4 v[124:127], v5, s[24:27], s13 offen offset:3072
    v_mov_b32 v7, v0
    s_waitcnt vmcnt(7)
    v_mfma_f32_16x16x32_bf16 v[16:19], v[32:35], v[96:99], 0
    v_mfma_f32_16x16x32_bf16 v[20:23], v[36:39], v[96:99], 0
    v_mfma_f32_16x16x32_bf16 v[24:27], v[40:43], v[96:99], 0
    v_mfma_f32_16x16x32_bf16 v[28:31], v[44:47], v[96:99], 0
    s_lshl_b32 s29, s45, 14
    v_add_u32 v12, s29, v12
    v_add_u32 v13, s29, v13
    v_add_u32 v14, s29, v14
    v_add_u32 v15, s29, v15
    ds_read_b64_tr_b16 v[32:33], v12 offset:16384
    ds_read_b64_tr_b16 v[34:35], v12 offset:16896
    ds_read_b64_tr_b16 v[36:37], v13 offset:16384
    ds_read_b64_tr_b16 v[38:39], v13 offset:16896
    ds_read_b64_tr_b16 v[40:41], v14 offset:16384
    ds_read_b64_tr_b16 v[42:43], v14 offset:16896
    ds_read_b64_tr_b16 v[44:45], v15 offset:16384
    ds_read_b64_tr_b16 v[46:47], v15 offset:16896
    s_waitcnt vmcnt(6)
    v_mfma_f32_16x16x32_bf16 v[16:19], v[48:51], v[100:103], v[16:19]
    v_mfma_f32_16x16x32_bf16 v[20:23], v[52:55], v[100:103], v[20:23]
    v_mfma_f32_16x16x32_bf16 v[24:27], v[56:59], v[100:103], v[24:27]
    v_mfma_f32_16x16x32_bf16 v[28:31], v[60:63], v[100:103], v[28:31]
    s_waitcnt lgkmcnt(7)
    ds_read_b64_tr_b16 v[48:49], v12 offset:20480
    ds_read_b64_tr_b16 v[50:51], v12 offset:20992
    ds_read_b64_tr_b16 v[52:53], v13 offset:20480
    ds_read_b64_tr_b16 v[54:55], v13 offset:20992
    ds_read_b64_tr_b16 v[56:57], v14 offset:20480
    ds_read_b64_tr_b16 v[58:59], v14 offset:20992
    ds_read_b64_tr_b16 v[60:61], v15 offset:20480
    ds_read_b64_tr_b16 v[62:63], v15 offset:20992
    s_waitcnt vmcnt(5)
    v_mfma_f32_16x16x32_bf16 v[16:19], v[64:67], v[104:107], v[16:19]
    v_mfma_f32_16x16x32_bf16 v[20:23], v[68:71], v[104:107], v[20:23]
    v_mfma_f32_16x16x32_bf16 v[24:27], v[72:75], v[104:107], v[24:27]
    v_mfma_f32_16x16x32_bf16 v[28:31], v[76:79], v[104:107], v[28:31]
    s_waitcnt vmcnt(4)
    v_mfma_f32_16x16x32_bf16 v[16:19], v[80:83], v[108:111], v[16:19]
    v_mfma_f32_16x16x32_bf16 v[20:23], v[84:87], v[108:111], v[20:23]
    v_mfma_f32_16x16x32_bf16 v[24:27], v[88:91], v[108:111], v[24:27]
    v_mfma_f32_16x16x32_bf16 v[28:31], v[92:95], v[108:111], v[28:31]
    s_waitcnt lgkmcnt(7)
    ds_read_b64_tr_b16 v[64:65], v12 offset:24576
    ds_read_b64_tr_b16 v[66:67], v12 offset:25088
    ds_read_b64_tr_b16 v[68:69], v13 offset:24576
    ds_read_b64_tr_b16 v[70:71], v13 offset:25088
    ds_read_b64_tr_b16 v[72:73], v14 offset:24576
    ds_read_b64_tr_b16 v[74:75], v14 offset:25088
    ds_read_b64_tr_b16 v[76:77], v15 offset:24576
    ds_read_b64_tr_b16 v[78:79], v15 offset:25088
    s_waitcnt vmcnt(3)
    v_mfma_f32_16x16x32_bf16 v[16:19], v[32:35], v[112:115], v[16:19]
    v_mfma_f32_16x16x32_bf16 v[20:23], v[36:39], v[112:115], v[20:23]
    v_mfma_f32_16x16x32_bf16 v[24:27], v[40:43], v[112:115], v[24:27]
    v_mfma_f32_16x16x32_bf16 v[28:31], v[44:47], v[112:115], v[28:31]
    s_waitcnt lgkmcnt(7)
    ds_read_b64_tr_b16 v[80:81], v12 offset:28672
    ds_read_b64_tr_b16 v[82:83], v12 offset:29184
    ds_read_b64_tr_b16 v[84:85], v13 offset:28672
    ds_read_b64_tr_b16 v[86:87], v13 offset:29184
    ds_read_b64_tr_b16 v[88:89], v14 offset:28672
    ds_read_b64_tr_b16 v[90:91], v14 offset:29184
    ds_read_b64_tr_b16 v[92:93], v15 offset:28672
    ds_read_b64_tr_b16 v[94:95], v15 offset:29184
    s_waitcnt vmcnt(2)
    v_mfma_f32_16x16x32_bf16 v[16:19], v[48:51], v[116:119], v[16:19]
    v_mfma_f32_16x16x32_bf16 v[20:23], v[52:55], v[116:119], v[20:23]
    v_mfma_f32_16x16x32_bf16 v[24:27], v[56:59], v[116:119], v[24:27]
    v_mfma_f32_16x16x32_bf16 v[28:31], v[60:63], v[116:119], v[28:31]
    s_waitcnt lgkmcnt(8)
    s_waitcnt vmcnt(1)
    v_mfma_f32_16x16x32_bf16 v[16:19], v[64:67], v[120:123], v[16:19]
    v_mfma_f32_16x16x32_bf16 v[20:23], v[68:71], v[120:123], v[20:23]
    v_mfma_f32_16x16x32_bf16 v[24:27], v[72:75], v[120:123], v[24:27]
    v_mfma_f32_16x16x32_bf16 v[28:31], v[76:79], v[120:123], v[28:31]
    s_waitcnt lgkmcnt(0)
    s_waitcnt vmcnt(0)
    v_mfma_f32_16x16x32_bf16 v[16:19], v[80:83], v[124:127], v[16:19]
    v_mfma_f32_16x16x32_bf16 v[20:23], v[84:87], v[124:127], v[20:23]
    v_mfma_f32_16x16x32_bf16 v[24:27], v[88:91], v[124:127], v[24:27]
    v_mfma_f32_16x16x32_bf16 v[28:31], v[92:95], v[124:127], v[28:31]
    s_barrier
    s_nop 4
    s_cmp_eq_u32 s45, 0
    s_cbranch_scc1 OUT_lo
    ds_write_b128 v10, v[16:19]
    ds_write_b128 v10, v[20:23] offset:1024

    v_mov_b32 v16, v24
    v_mov_b32 v17, v25
    v_mov_b32 v18, v26
    v_mov_b32 v19, v27
    v_mov_b32 v20, v28
    v_mov_b32 v21, v29
    v_mov_b32 v22, v30
    v_mov_b32 v23, v31
    s_branch OUT_x
OUT_lo:
    ds_write_b128 v10, v[24:27]
    ds_write_b128 v10, v[28:31] offset:1024

OUT_x:
    s_waitcnt lgkmcnt(0)
    s_barrier
    ds_read_b128 v[32:35], v11
    ds_read_b128 v[36:39], v11 offset:1024
    s_waitcnt lgkmcnt(0)

    v_add_f32 v16, v16, v32
    v_add_f32 v17, v17, v33
    v_add_f32 v18, v18, v34
    v_add_f32 v19, v19, v35
    v_add_f32 v20, v20, v36
    v_add_f32 v21, v21, v37
    v_add_f32 v22, v22, v38
    v_add_f32 v23, v23, v39
    v_cvt_pk_bf16_f32 v32, v16, v17
    v_cvt_pk_bf16_f32 v33, v18, v19
    v_cvt_pk_bf16_f32 v34, v20, v21
    v_cvt_pk_bf16_f32 v35, v22, v23
    s_nop 1
    v_permlane16_swap_b32 v32, v34
    v_permlane16_swap_b32 v33, v35
    s_nop 1
    buffer_store_dwordx4 v[32:35], v7, s[32:35], s15 offen sc0 sc1

    s_endpgm
ROLE_B:
    s_cmp_ge_u32 s82, 480
    s_cbranch_scc1 ROLE_P

    s_setprio 0
    s_sub_u32 s2, s82, 256

    s_getreg_b32 s6, hwreg(HW_REG_XCC_ID)
    s_bitcmp1_b32 s6, 0
    s_movk_i32 s6, 300
    s_cmovk_i32 s6, 200

B_dly:
    s_sleep 4
    s_memrealtime s[4:5]
    s_waitcnt lgkmcnt(0)
    s_sub_u32 s4, s4, s84
    s_cmp_lt_u32 s4, s6
    s_cbranch_scc1 B_dly

DFT_ENTRY:
    s_mov_b32 s3, s2
    s_mov_b64 s[36:37], s[68:69]
    s_mov_b64 s[38:39], s[70:71]
    s_mov_b64 s[40:41], s[72:73]
    s_mov_b64 s[42:43], s[74:75]
    s_mov_b64 s[60:61], s[76:77]
    s_mov_b64 s[62:63], s[78:79]

    s_and_b32 s12, s2, 31
    s_lshr_b32 s13, s2, 5
    s_cmp_ge_u32 s12, 16
    s_cselect_b32 s16, s42, s40
    s_cselect_b32 s17, s43, s41
    s_mov_b32 s18, 8388608
    s_mov_b32 s19, 0x00020000
    s_and_b32 s44, s10, 1
    s_lshr_b32 s45, s10, 1
    s_and_b32 s51, s12, 7
    s_lshl_b32 s51, s51, 2
    s_mul_i32 s52, s13, 0
    s_add_u32 s52, s51, s52
    s_and_b32 s52, s52, 31
    s_and_b32 s51, s51, 31
    s_and_b32 s14, s12, 15
    s_lshl_b32 s14, s14, 19
    v_and_b32 v3, 31, v1
    v_lshrrev_b32 v4, 5, v1

    s_lshl_b32 s46, s44, 13
    s_lshl_b32 s47, s45, 1
    s_and_b32 s47, s47, 4
    v_add_u32 v2, s47, v4
    v_bfe_u32 v6, v1, 1, 3
    v_xor_b32 v2, v2, v6
    v_lshlrev_b32 v2, 4, v2
    v_lshl_add_u32 v2, v3, 7, v2
    v_add_u32 v104, s46, v2
    v_and_b32 v6, 15, v1
    v_lshrrev_b32 v6, 2, v6
    v_lshl_add_u32 v6, v4, 3, v6
    v_lshlrev_b32 v6, 7, v6
    v_bfe_u32 v7, v1, 3, 1
    v_lshl_add_u32 v6, v7, 6, v6
    v_bfe_u32 v7, v1, 4, 1
    v_lshl_add_u32 v6, v7, 5, v6
    v_bfe_u32 v7, v1, 0, 1
    v_lshl_add_u32 v6, v7, 4, v6
    v_bfe_u32 v7, v1, 1, 1
    v_lshl_add_u32 v6, v7, 3, v6
    s_lshl_b32 s47, s45, 11
    s_and_b32 s47, s47, 4096
    s_add_u32 s47, s47, 16384
    v_add_u32 v105, s47, v6
    v_xor_b32 v106, 64, v105
    s_and_b32 s47, s45, 1
    s_lshl_b32 s47, s47, 6
    v_xor_b32 v105, s47, v105
    v_xor_b32 v106, 32, v104
    s_mov_b32 s48, 0

    s_cmp_ge_u32 s10, 6
    s_cbranch_scc1 DFT_touch

    v_lshrrev_b32 v6, 3, v1
    v_and_b32 v7, 7, v1
    v_lshrrev_b32 v2, 4, v1
    v_xor_b32 v2, v7, v2
    v_lshlrev_b32 v2, 4, v2
    v_lshl_add_u32 v107, v6, 12, v2
    v_xor_b32 v108, 64, v107
    s_lshl_b32 s15, s10, 17
    s_add_u32 s14, s14, s15
    s_mov_b32 s53, 32768
    s_mov_b32 s54, 128
    s_mov_b32 s55, 16384
    s_lshl_b32 s28, s10, 12
    s_cmp_lt_u32 s10, 4
    s_cbranch_scc1 DFT_cw
    v_bfe_u32 v2, v1, 4, 1
    v_lshlrev_b32 v2, 2, v2
    v_xor_b32 v2, v7, v2
    v_lshlrev_b32 v2, 4, v2
    v_mul_u32_u24 v107, 896, v6
    v_add_u32 v107, v107, v2
    v_mov_b32 v108, v107
    s_mov_b32 s16, s38
    s_mov_b32 s17, s39
    s_mov_b32 s18, 1835008
    s_sub_u32 s15, s10, 4
    s_mul_i32 s14, s15, 28672
    s_lshl_b32 s29, s13, 7
    s_add_u32 s14, s14, s29
    s_mov_b32 s53, 7168
    s_mov_b32 s54, 57344
    s_mov_b32 s55, 8192
    s_lshl_b32 s28, s15, 12
    s_add_u32 s28, s28, 49152

DFT_cw:
    s_add_u32 s56, s28, s55
    s_add_u32 s57, s56, s55

    s_mul_i32 s36, s52, s54
    s_mov_b32 m0, s28
    s_add_u32 s36, s36, s14
    s_add_u32 s52, s52, 1
    buffer_load_dwordx4 v107, s[16:19], s36 offen lds
    s_add_u32 m0, s28, 1024
    s_add_u32 s36, s36, s53
    s_and_b32 s52, s52, 31
    buffer_load_dwordx4 v108, s[16:19], s36 offen lds
    s_add_u32 m0, s28, 2048
    s_add_u32 s36, s36, s53
    buffer_load_dwordx4 v107, s[16:19], s36 offen lds
    s_add_u32 m0, s28, 3072
    s_add_u32 s36, s36, s53
    buffer_load_dwordx4 v108, s[16:19], s36 offen lds

    s_mul_i32 s36, s52, s54
    s_mov_b32 m0, s56
    s_add_u32 s36, s36, s14
    s_add_u32 s52, s52, 1
    buffer_load_dwordx4 v107, s[16:19], s36 offen lds
    s_add_u32 m0, s56, 1024
    s_add_u32 s36, s36, s53
    s_and_b32 s52, s52, 31
    buffer_load_dwordx4 v108, s[16:19], s36 offen lds
    s_add_u32 m0, s56, 2048
    s_add_u32 s36, s36, s53
    buffer_load_dwordx4 v107, s[16:19], s36 offen lds
    s_add_u32 m0, s56, 3072
    s_add_u32 s36, s36, s53
    buffer_load_dwordx4 v108, s[16:19], s36 offen lds

    v_mov_b32 v8, 0
    v_mov_b32 v9, 0
    v_mov_b32 v10, 0
    v_mov_b32 v11, 0
    v_mov_b32 v12, 0
    v_mov_b32 v13, 0
    v_mov_b32 v14, 0
    v_mov_b32 v15, 0
    v_mov_b32 v16, 0
    v_mov_b32 v17, 0
    v_mov_b32 v18, 0
    v_mov_b32 v19, 0
    v_mov_b32 v20, 0
    v_mov_b32 v21, 0
    v_mov_b32 v22, 0
    v_mov_b32 v23, 0
    v_mov_b32 v24, 0
    v_mov_b32 v25, 0
    v_mov_b32 v26, 0
    v_mov_b32 v27, 0
    v_mov_b32 v28, 0
    v_mov_b32 v29, 0
    v_mov_b32 v30, 0
    v_mov_b32 v31, 0
    v_mov_b32 v32, 0
    v_mov_b32 v33, 0
    v_mov_b32 v34, 0
    v_mov_b32 v35, 0
    v_mov_b32 v36, 0
    v_mov_b32 v37, 0
    v_mov_b32 v38, 0
    v_mov_b32 v39, 0
    s_cmp_ge_u32 s12, 16
    s_cselect_b32 s49, 0x80008000, 0
    s_cselect_b32 s50, 56, 0
    s_and_b32 s58, s12, 15
    s_lshl_b32 s58, s58, 3
    s_lshl_b32 s5, s44, 2
    s_add_u32 s58, s58, s5
    s_lshr_b32 s5, s45, 1
    s_lshl_b32 s5, s5, 1
    s_add_u32 s58, s58, s5
    s_mul_i32 s58, s58, 112
    s_add_u32 s58, s58, s50
    s_lshl_b32 s5, s13, 3
    s_add_u32 s58, s58, s5
    s_and_b32 s5, s45, 1
    s_lshl_b32 s5, s5, 2
    s_add_u32 s58, s58, s5
    s_lshl_b32 s58, s58, 8
    s_add_u32 s58, s58, 8388608
    v_and_b32 v111, 15, v1
    v_lshlrev_b32 v111, 4, v111
    v_lshl_add_u32 v111, v4, 8, v111
    v_bfe_u32 v112, v1, 4, 1
    v_mul_u32_u24 v112, 28672, v112
    v_add_u32 v111, v111, v112
    s_and_b32 s4, s10, 3
    s_lshl_b32 s4, s4, 12
    s_lshr_b32 s5, s10, 2
    s_lshl_b32 s5, s5, 15
    s_add_u32 s4, s4, s5
    v_add_u32 v112, s4, v5
    v_xor_b32 v113, 32768, v112

    s_waitcnt vmcnt(4) lgkmcnt(0)
    s_barrier
    ds_read_b64_tr_b16 v[48:49], v105 offset:32768
    ds_read_b64_tr_b16 v[50:51], v105 offset:33280
    ds_read_b128 v[40:43], v104 offset:0
    ds_read_b128 v[44:47], v104 offset:4096
    ds_read_b64_tr_b16 v[60:61], v105 offset:34816
    ds_read_b64_tr_b16 v[62:63], v105 offset:35328
    ds_read_b128 v[52:55], v106 offset:0
    ds_read_b128 v[56:59], v106 offset:4096
    s_mul_i32 s36, s52, s54
    s_mov_b32 m0, s57
    s_add_u32 s36, s36, s14
    s_add_u32 s52, s52, 1
    buffer_load_dwordx4 v107, s[16:19], s36 offen lds
    s_add_u32 m0, s57, 1024
    s_add_u32 s36, s36, s53
    s_and_b32 s52, s52, 31
    buffer_load_dwordx4 v108, s[16:19], s36 offen lds
    s_add_u32 m0, s57, 2048
    s_add_u32 s36, s36, s53
    buffer_load_dwordx4 v107, s[16:19], s36 offen lds
    s_add_u32 m0, s57, 3072
    s_add_u32 s36, s36, s53
    buffer_load_dwordx4 v108, s[16:19], s36 offen lds

DFT_loop:
    s_waitcnt vmcnt(4) lgkmcnt(0)
    s_barrier
    ds_read_b64_tr_b16 v[72:73], v105 offset:40960
    ds_read_b64_tr_b16 v[74:75], v105 offset:41472
    ds_read_b128 v[64:67], v104 offset:16384
    ds_read_b128 v[68:71], v104 offset:20480
    ds_read_b64_tr_b16 v[84:85], v105 offset:43008
    ds_read_b64_tr_b16 v[86:87], v105 offset:43520
    ds_read_b128 v[76:79], v106 offset:16384
    ds_read_b128 v[80:83], v106 offset:20480
    s_mul_i32 s36, s52, s54
    s_mov_b32 m0, s28
    s_add_u32 s36, s36, s14
    s_add_u32 s52, s52, 1
    buffer_load_dwordx4 v107, s[16:19], s36 offen lds
    s_add_u32 m0, s28, 1024
    s_add_u32 s36, s36, s53
    s_and_b32 s52, s52, 31
    buffer_load_dwordx4 v108, s[16:19], s36 offen lds
    s_add_u32 m0, s28, 2048
    s_add_u32 s36, s36, s53
    buffer_load_dwordx4 v107, s[16:19], s36 offen lds
    s_add_u32 m0, s28, 3072
    s_add_u32 s36, s36, s53
    buffer_load_dwordx4 v108, s[16:19], s36 offen lds

    v_mfma_f32_32x32x16_bf16 v[8:23], v[48:51], v[40:43], v[8:23]
    v_mfma_f32_32x32x16_bf16 v[24:39], v[48:51], v[44:47], v[24:39]
    v_mfma_f32_32x32x16_bf16 v[8:23], v[60:63], v[52:55], v[8:23]
    v_mfma_f32_32x32x16_bf16 v[24:39], v[60:63], v[56:59], v[24:39]
    s_waitcnt vmcnt(4) lgkmcnt(0)
    s_barrier
    ds_read_b64_tr_b16 v[48:49], v105 offset:49152
    ds_read_b64_tr_b16 v[50:51], v105 offset:49664
    ds_read_b128 v[40:43], v104 offset:32768
    ds_read_b128 v[44:47], v104 offset:36864
    ds_read_b64_tr_b16 v[60:61], v105 offset:51200
    ds_read_b64_tr_b16 v[62:63], v105 offset:51712
    ds_read_b128 v[52:55], v106 offset:32768
    ds_read_b128 v[56:59], v106 offset:36864
    s_mul_i32 s36, s52, s54
    s_mov_b32 m0, s56
    s_add_u32 s36, s36, s14
    s_add_u32 s52, s52, 1
    buffer_load_dwordx4 v107, s[16:19], s36 offen lds
    s_add_u32 m0, s56, 1024
    s_add_u32 s36, s36, s53
    s_and_b32 s52, s52, 31
    buffer_load_dwordx4 v108, s[16:19], s36 offen lds
    s_add_u32 m0, s56, 2048
    s_add_u32 s36, s36, s53
    buffer_load_dwordx4 v107, s[16:19], s36 offen lds
    s_add_u32 m0, s56, 3072
    s_add_u32 s36, s36, s53
    buffer_load_dwordx4 v108, s[16:19], s36 offen lds

    v_mfma_f32_32x32x16_bf16 v[8:23], v[72:75], v[64:67], v[8:23]
    v_mfma_f32_32x32x16_bf16 v[24:39], v[72:75], v[68:71], v[24:39]
    v_mfma_f32_32x32x16_bf16 v[8:23], v[84:87], v[76:79], v[8:23]
    v_mfma_f32_32x32x16_bf16 v[24:39], v[84:87], v[80:83], v[24:39]
    s_waitcnt vmcnt(4) lgkmcnt(0)
    s_barrier
    ds_read_b64_tr_b16 v[72:73], v105 offset:32768
    ds_read_b64_tr_b16 v[74:75], v105 offset:33280
    ds_read_b128 v[64:67], v104 offset:0
    ds_read_b128 v[68:71], v104 offset:4096
    ds_read_b64_tr_b16 v[84:85], v105 offset:34816
    ds_read_b64_tr_b16 v[86:87], v105 offset:35328
    ds_read_b128 v[76:79], v106 offset:0
    ds_read_b128 v[80:83], v106 offset:4096
    s_mul_i32 s36, s52, s54
    s_mov_b32 m0, s57
    s_add_u32 s36, s36, s14
    s_add_u32 s52, s52, 1
    buffer_load_dwordx4 v107, s[16:19], s36 offen lds
    s_add_u32 m0, s57, 1024
    s_add_u32 s36, s36, s53
    s_and_b32 s52, s52, 31
    buffer_load_dwordx4 v108, s[16:19], s36 offen lds
    s_add_u32 m0, s57, 2048
    s_add_u32 s36, s36, s53
    buffer_load_dwordx4 v107, s[16:19], s36 offen lds
    s_add_u32 m0, s57, 3072
    s_add_u32 s36, s36, s53
    buffer_load_dwordx4 v108, s[16:19], s36 offen lds

    v_mfma_f32_32x32x16_bf16 v[8:23], v[48:51], v[40:43], v[8:23]
    v_mfma_f32_32x32x16_bf16 v[24:39], v[48:51], v[44:47], v[24:39]
    v_mfma_f32_32x32x16_bf16 v[8:23], v[60:63], v[52:55], v[8:23]
    v_mfma_f32_32x32x16_bf16 v[24:39], v[60:63], v[56:59], v[24:39]
    s_waitcnt vmcnt(4) lgkmcnt(0)
    s_barrier
    ds_read_b64_tr_b16 v[48:49], v105 offset:40960
    ds_read_b64_tr_b16 v[50:51], v105 offset:41472
    ds_read_b128 v[40:43], v104 offset:16384
    ds_read_b128 v[44:47], v104 offset:20480
    ds_read_b64_tr_b16 v[60:61], v105 offset:43008
    ds_read_b64_tr_b16 v[62:63], v105 offset:43520
    ds_read_b128 v[52:55], v106 offset:16384
    ds_read_b128 v[56:59], v106 offset:20480
    s_mul_i32 s36, s52, s54
    s_mov_b32 m0, s28
    s_add_u32 s36, s36, s14
    s_add_u32 s52, s52, 1
    buffer_load_dwordx4 v107, s[16:19], s36 offen lds
    s_add_u32 m0, s28, 1024
    s_add_u32 s36, s36, s53
    s_and_b32 s52, s52, 31
    buffer_load_dwordx4 v108, s[16:19], s36 offen lds
    s_add_u32 m0, s28, 2048
    s_add_u32 s36, s36, s53
    buffer_load_dwordx4 v107, s[16:19], s36 offen lds
    s_add_u32 m0, s28, 3072
    s_add_u32 s36, s36, s53
    buffer_load_dwordx4 v108, s[16:19], s36 offen lds

    v_mfma_f32_32x32x16_bf16 v[8:23], v[72:75], v[64:67], v[8:23]
    v_mfma_f32_32x32x16_bf16 v[24:39], v[72:75], v[68:71], v[24:39]
    v_mfma_f32_32x32x16_bf16 v[8:23], v[84:87], v[76:79], v[8:23]
    v_mfma_f32_32x32x16_bf16 v[24:39], v[84:87], v[80:83], v[24:39]
    s_waitcnt vmcnt(4) lgkmcnt(0)
    s_barrier
    ds_read_b64_tr_b16 v[72:73], v105 offset:49152
    ds_read_b64_tr_b16 v[74:75], v105 offset:49664
    ds_read_b128 v[64:67], v104 offset:32768
    ds_read_b128 v[68:71], v104 offset:36864
    ds_read_b64_tr_b16 v[84:85], v105 offset:51200
    ds_read_b64_tr_b16 v[86:87], v105 offset:51712
    ds_read_b128 v[76:79], v106 offset:32768
    ds_read_b128 v[80:83], v106 offset:36864
    s_mul_i32 s36, s52, s54
    s_mov_b32 m0, s56
    s_add_u32 s36, s36, s14
    s_add_u32 s52, s52, 1
    buffer_load_dwordx4 v107, s[16:19], s36 offen lds
    s_add_u32 m0, s56, 1024
    s_add_u32 s36, s36, s53
    s_and_b32 s52, s52, 31
    buffer_load_dwordx4 v108, s[16:19], s36 offen lds
    s_add_u32 m0, s56, 2048
    s_add_u32 s36, s36, s53
    buffer_load_dwordx4 v107, s[16:19], s36 offen lds
    s_add_u32 m0, s56, 3072
    s_add_u32 s36, s36, s53
    buffer_load_dwordx4 v108, s[16:19], s36 offen lds

    v_mfma_f32_32x32x16_bf16 v[8:23], v[48:51], v[40:43], v[8:23]
    v_mfma_f32_32x32x16_bf16 v[24:39], v[48:51], v[44:47], v[24:39]
    v_mfma_f32_32x32x16_bf16 v[8:23], v[60:63], v[52:55], v[8:23]
    v_mfma_f32_32x32x16_bf16 v[24:39], v[60:63], v[56:59], v[24:39]
    s_waitcnt vmcnt(4) lgkmcnt(0)
    s_barrier
    ds_read_b64_tr_b16 v[48:49], v105 offset:32768
    ds_read_b64_tr_b16 v[50:51], v105 offset:33280
    ds_read_b128 v[40:43], v104 offset:0
    ds_read_b128 v[44:47], v104 offset:4096
    ds_read_b64_tr_b16 v[60:61], v105 offset:34816
    ds_read_b64_tr_b16 v[62:63], v105 offset:35328
    ds_read_b128 v[52:55], v106 offset:0
    ds_read_b128 v[56:59], v106 offset:4096
    s_mul_i32 s36, s52, s54
    s_mov_b32 m0, s57
    s_add_u32 s36, s36, s14
    s_add_u32 s52, s52, 1
    buffer_load_dwordx4 v107, s[16:19], s36 offen lds
    s_add_u32 m0, s57, 1024
    s_add_u32 s36, s36, s53
    s_and_b32 s52, s52, 31
    buffer_load_dwordx4 v108, s[16:19], s36 offen lds
    s_add_u32 m0, s57, 2048
    s_add_u32 s36, s36, s53
    buffer_load_dwordx4 v107, s[16:19], s36 offen lds
    s_add_u32 m0, s57, 3072
    s_add_u32 s36, s36, s53
    buffer_load_dwordx4 v108, s[16:19], s36 offen lds

    v_mfma_f32_32x32x16_bf16 v[8:23], v[72:75], v[64:67], v[8:23]
    v_mfma_f32_32x32x16_bf16 v[24:39], v[72:75], v[68:71], v[24:39]
    v_mfma_f32_32x32x16_bf16 v[8:23], v[84:87], v[76:79], v[8:23]
    v_mfma_f32_32x32x16_bf16 v[24:39], v[84:87], v[80:83], v[24:39]
    s_add_u32 s48, s48, 1
    s_cmp_lt_u32 s48, 4
    s_cbranch_scc1 DFT_loop

    s_waitcnt vmcnt(4) lgkmcnt(0)
    s_barrier
    ds_read_b64_tr_b16 v[72:73], v105 offset:40960
    ds_read_b64_tr_b16 v[74:75], v105 offset:41472
    ds_read_b128 v[64:67], v104 offset:16384
    ds_read_b128 v[68:71], v104 offset:20480
    ds_read_b64_tr_b16 v[84:85], v105 offset:43008
    ds_read_b64_tr_b16 v[86:87], v105 offset:43520
    ds_read_b128 v[76:79], v106 offset:16384
    ds_read_b128 v[80:83], v106 offset:20480
    s_mul_i32 s36, s52, s54
    s_mov_b32 m0, s28
    s_add_u32 s36, s36, s14
    s_add_u32 s52, s52, 1
    buffer_load_dwordx4 v107, s[16:19], s36 offen lds
    s_add_u32 m0, s28, 1024
    s_add_u32 s36, s36, s53
    s_and_b32 s52, s52, 31
    buffer_load_dwordx4 v108, s[16:19], s36 offen lds
    s_add_u32 m0, s28, 2048
    s_add_u32 s36, s36, s53
    buffer_load_dwordx4 v107, s[16:19], s36 offen lds
    s_add_u32 m0, s28, 3072
    s_add_u32 s36, s36, s53
    buffer_load_dwordx4 v108, s[16:19], s36 offen lds

    v_mfma_f32_32x32x16_bf16 v[8:23], v[48:51], v[40:43], v[8:23]
    v_mfma_f32_32x32x16_bf16 v[24:39], v[48:51], v[44:47], v[24:39]
    v_mfma_f32_32x32x16_bf16 v[8:23], v[60:63], v[52:55], v[8:23]
    v_mfma_f32_32x32x16_bf16 v[24:39], v[60:63], v[56:59], v[24:39]
    s_waitcnt vmcnt(4) lgkmcnt(0)
    s_barrier
    ds_read_b64_tr_b16 v[48:49], v105 offset:49152
    ds_read_b64_tr_b16 v[50:51], v105 offset:49664
    ds_read_b128 v[40:43], v104 offset:32768
    ds_read_b128 v[44:47], v104 offset:36864
    ds_read_b64_tr_b16 v[60:61], v105 offset:51200
    ds_read_b64_tr_b16 v[62:63], v105 offset:51712
    ds_read_b128 v[52:55], v106 offset:32768
    ds_read_b128 v[56:59], v106 offset:36864
    s_mul_i32 s36, s52, s54
    s_mov_b32 m0, s56
    s_add_u32 s36, s36, s14
    s_add_u32 s52, s52, 1
    buffer_load_dwordx4 v107, s[16:19], s36 offen lds
    s_add_u32 m0, s56, 1024
    s_add_u32 s36, s36, s53
    s_and_b32 s52, s52, 31
    buffer_load_dwordx4 v108, s[16:19], s36 offen lds
    s_add_u32 m0, s56, 2048
    s_add_u32 s36, s36, s53
    buffer_load_dwordx4 v107, s[16:19], s36 offen lds
    s_add_u32 m0, s56, 3072
    s_add_u32 s36, s36, s53
    buffer_load_dwordx4 v108, s[16:19], s36 offen lds

    v_mfma_f32_32x32x16_bf16 v[8:23], v[72:75], v[64:67], v[8:23]
    v_mfma_f32_32x32x16_bf16 v[24:39], v[72:75], v[68:71], v[24:39]
    v_mfma_f32_32x32x16_bf16 v[8:23], v[84:87], v[76:79], v[8:23]
    v_mfma_f32_32x32x16_bf16 v[24:39], v[84:87], v[80:83], v[24:39]
    s_waitcnt vmcnt(4) lgkmcnt(0)
    s_barrier
    ds_read_b64_tr_b16 v[72:73], v105 offset:32768
    ds_read_b64_tr_b16 v[74:75], v105 offset:33280
    ds_read_b128 v[64:67], v104 offset:0
    ds_read_b128 v[68:71], v104 offset:4096
    ds_read_b64_tr_b16 v[84:85], v105 offset:34816
    ds_read_b64_tr_b16 v[86:87], v105 offset:35328
    ds_read_b128 v[76:79], v106 offset:0
    ds_read_b128 v[80:83], v106 offset:4096
    s_mul_i32 s36, s52, s54
    s_mov_b32 m0, s57
    s_add_u32 s36, s36, s14
    s_add_u32 s52, s52, 1
    buffer_load_dwordx4 v107, s[16:19], s36 offen lds
    s_add_u32 m0, s57, 1024
    s_add_u32 s36, s36, s53
    s_and_b32 s52, s52, 31
    buffer_load_dwordx4 v108, s[16:19], s36 offen lds
    s_add_u32 m0, s57, 2048
    s_add_u32 s36, s36, s53
    buffer_load_dwordx4 v107, s[16:19], s36 offen lds
    s_add_u32 m0, s57, 3072
    s_add_u32 s36, s36, s53
    buffer_load_dwordx4 v108, s[16:19], s36 offen lds

    v_mfma_f32_32x32x16_bf16 v[8:23], v[48:51], v[40:43], v[8:23]
    v_mfma_f32_32x32x16_bf16 v[24:39], v[48:51], v[44:47], v[24:39]
    v_mfma_f32_32x32x16_bf16 v[8:23], v[60:63], v[52:55], v[8:23]
    v_mfma_f32_32x32x16_bf16 v[24:39], v[60:63], v[56:59], v[24:39]
    s_waitcnt vmcnt(4) lgkmcnt(0)
    s_barrier
    ds_read_b64_tr_b16 v[48:49], v105 offset:40960
    ds_read_b64_tr_b16 v[50:51], v105 offset:41472
    ds_read_b128 v[40:43], v104 offset:16384
    ds_read_b128 v[44:47], v104 offset:20480
    ds_read_b64_tr_b16 v[60:61], v105 offset:43008
    ds_read_b64_tr_b16 v[62:63], v105 offset:43520
    ds_read_b128 v[52:55], v106 offset:16384
    ds_read_b128 v[56:59], v106 offset:20480
    s_mul_i32 s36, s52, s54
    s_mov_b32 m0, s28
    s_add_u32 s36, s36, s14
    s_add_u32 s52, s52, 1
    buffer_load_dwordx4 v107, s[16:19], s36 offen lds
    s_add_u32 m0, s28, 1024
    s_add_u32 s36, s36, s53
    s_and_b32 s52, s52, 31
    buffer_load_dwordx4 v108, s[16:19], s36 offen lds
    s_add_u32 m0, s28, 2048
    s_add_u32 s36, s36, s53
    buffer_load_dwordx4 v107, s[16:19], s36 offen lds
    s_add_u32 m0, s28, 3072
    s_add_u32 s36, s36, s53
    buffer_load_dwordx4 v108, s[16:19], s36 offen lds

    v_mfma_f32_32x32x16_bf16 v[8:23], v[72:75], v[64:67], v[8:23]
    v_mfma_f32_32x32x16_bf16 v[24:39], v[72:75], v[68:71], v[24:39]
    v_mfma_f32_32x32x16_bf16 v[8:23], v[84:87], v[76:79], v[8:23]
    v_mfma_f32_32x32x16_bf16 v[24:39], v[84:87], v[80:83], v[24:39]
    s_waitcnt vmcnt(4) lgkmcnt(0)
    s_barrier
    ds_read_b64_tr_b16 v[72:73], v105 offset:49152
    ds_read_b64_tr_b16 v[74:75], v105 offset:49664
    ds_read_b128 v[64:67], v104 offset:32768
    ds_read_b128 v[68:71], v104 offset:36864
    ds_read_b64_tr_b16 v[84:85], v105 offset:51200
    ds_read_b64_tr_b16 v[86:87], v105 offset:51712
    ds_read_b128 v[76:79], v106 offset:32768
    ds_read_b128 v[80:83], v106 offset:36864
    s_mul_i32 s36, s52, s54
    s_mov_b32 m0, s56
    s_add_u32 s36, s36, s14
    s_add_u32 s52, s52, 1
    buffer_load_dwordx4 v107, s[16:19], s36 offen lds
    s_add_u32 m0, s56, 1024
    s_add_u32 s36, s36, s53
    s_and_b32 s52, s52, 31
    buffer_load_dwordx4 v108, s[16:19], s36 offen lds
    s_add_u32 m0, s56, 2048
    s_add_u32 s36, s36, s53
    buffer_load_dwordx4 v107, s[16:19], s36 offen lds
    s_add_u32 m0, s56, 3072
    s_add_u32 s36, s36, s53
    buffer_load_dwordx4 v108, s[16:19], s36 offen lds

    v_mfma_f32_32x32x16_bf16 v[8:23], v[48:51], v[40:43], v[8:23]
    v_mfma_f32_32x32x16_bf16 v[24:39], v[48:51], v[44:47], v[24:39]
    v_mfma_f32_32x32x16_bf16 v[8:23], v[60:63], v[52:55], v[8:23]
    v_mfma_f32_32x32x16_bf16 v[24:39], v[60:63], v[56:59], v[24:39]
    s_waitcnt vmcnt(4) lgkmcnt(0)
    s_barrier
    ds_read_b64_tr_b16 v[48:49], v105 offset:32768
    ds_read_b64_tr_b16 v[50:51], v105 offset:33280
    ds_read_b128 v[40:43], v104 offset:0
    ds_read_b128 v[44:47], v104 offset:4096
    ds_read_b64_tr_b16 v[60:61], v105 offset:34816
    ds_read_b64_tr_b16 v[62:63], v105 offset:35328
    ds_read_b128 v[52:55], v106 offset:0
    ds_read_b128 v[56:59], v106 offset:4096
    v_mfma_f32_32x32x16_bf16 v[8:23], v[72:75], v[64:67], v[8:23]
    v_mfma_f32_32x32x16_bf16 v[24:39], v[72:75], v[68:71], v[24:39]
    v_mfma_f32_32x32x16_bf16 v[8:23], v[84:87], v[76:79], v[8:23]
    v_mfma_f32_32x32x16_bf16 v[24:39], v[84:87], v[80:83], v[24:39]
    s_waitcnt vmcnt(0) lgkmcnt(0)
    s_barrier
    ds_read_b64_tr_b16 v[72:73], v105 offset:40960
    ds_read_b64_tr_b16 v[74:75], v105 offset:41472
    ds_read_b128 v[64:67], v104 offset:16384
    ds_read_b128 v[68:71], v104 offset:20480
    ds_read_b64_tr_b16 v[84:85], v105 offset:43008
    ds_read_b64_tr_b16 v[86:87], v105 offset:43520
    ds_read_b128 v[76:79], v106 offset:16384
    ds_read_b128 v[80:83], v106 offset:20480
    v_mfma_f32_32x32x16_bf16 v[8:23], v[48:51], v[40:43], v[8:23]
    v_mfma_f32_32x32x16_bf16 v[24:39], v[48:51], v[44:47], v[24:39]
    v_mfma_f32_32x32x16_bf16 v[8:23], v[60:63], v[52:55], v[8:23]
    v_mfma_f32_32x32x16_bf16 v[24:39], v[60:63], v[56:59], v[24:39]
    s_branch DFT_red
DFT_touch:
    v_lshlrev_b32 v6, 12, v1
    s_add_u32 s28, s13, 4
    s_mov_b32 s29, 7
    s_mov_b32 s53, 64
    s_mov_b32 s54, 128
    s_mov_b32 s55, 262144
    s_cmp_eq_u32 s10, 6
    s_cbranch_scc1 DFT_tc
    v_mul_u32_u24 v6, 896, v1
    s_mov_b32 s16, s38
    s_mov_b32 s17, s39
    s_mov_b32 s18, 1835008
    s_lshl_b32 s14, s13, 7
    s_mov_b32 s51, s52
    s_lshr_b32 s28, s12, 3
    s_lshl_b32 s28, s28, 1
    s_add_u32 s28, s28, 4
    s_mov_b32 s29, 8
    s_mov_b32 s54, 57344

DFT_tc:
    v_mov_b32 v8, 0
    v_mov_b32 v9, 0
    v_mov_b32 v10, 0
    v_mov_b32 v11, 0
    v_mov_b32 v12, 0
    v_mov_b32 v13, 0
    v_mov_b32 v14, 0
    v_mov_b32 v15, 0
    v_mov_b32 v16, 0
    v_mov_b32 v17, 0
    v_mov_b32 v18, 0
    v_mov_b32 v19, 0
    v_mov_b32 v20, 0
    v_mov_b32 v21, 0
    v_mov_b32 v22, 0
    v_mov_b32 v23, 0
    v_mov_b32 v24, 0
    v_mov_b32 v25, 0
    v_mov_b32 v26, 0
    v_mov_b32 v27, 0
    v_mov_b32 v28, 0
    v_mov_b32 v29, 0
    v_mov_b32 v30, 0
    v_mov_b32 v31, 0
    v_mov_b32 v32, 0
    v_mov_b32 v33, 0
    v_mov_b32 v34, 0
    v_mov_b32 v35, 0
    v_mov_b32 v36, 0
    v_mov_b32 v37, 0
    v_mov_b32 v38, 0
    v_mov_b32 v39, 0
    s_cmp_ge_u32 s12, 16
    s_cselect_b32 s49, 0x80008000, 0
    s_cselect_b32 s50, 56, 0
    s_and_b32 s58, s12, 15
    s_lshl_b32 s58, s58, 3
    s_lshl_b32 s5, s44, 2
    s_add_u32 s58, s58, s5
    s_lshr_b32 s5, s45, 1
    s_lshl_b32 s5, s5, 1
    s_add_u32 s58, s58, s5
    s_mul_i32 s58, s58, 112
    s_add_u32 s58, s58, s50
    s_lshl_b32 s5, s13, 3
    s_add_u32 s58, s58, s5
    s_and_b32 s5, s45, 1
    s_lshl_b32 s5, s5, 2
    s_add_u32 s58, s58, s5
    s_lshl_b32 s58, s58, 8
    s_add_u32 s58, s58, 8388608
    v_and_b32 v111, 15, v1
    v_lshlrev_b32 v111, 4, v111
    v_lshl_add_u32 v111, v4, 8, v111
    v_bfe_u32 v112, v1, 4, 1
    v_mul_u32_u24 v112, 28672, v112
    v_add_u32 v111, v111, v112
    s_and_b32 s4, s10, 3
    s_lshl_b32 s4, s4, 12
    s_lshr_b32 s5, s10, 2
    s_lshl_b32 s5, s5, 15
    s_add_u32 s4, s4, s5
    v_add_u32 v112, s4, v5
    v_xor_b32 v113, 32768, v112

    s_waitcnt lgkmcnt(0)
    s_barrier
    ds_read_b64_tr_b16 v[48:49], v105 offset:32768
    ds_read_b64_tr_b16 v[50:51], v105 offset:33280
    ds_read_b128 v[40:43], v104 offset:0
    ds_read_b128 v[44:47], v104 offset:4096
    ds_read_b64_tr_b16 v[60:61], v105 offset:34816
    ds_read_b64_tr_b16 v[62:63], v105 offset:35328
    ds_read_b128 v[52:55], v106 offset:0
    ds_read_b128 v[56:59], v106 offset:4096
DFT_loopT:
    s_waitcnt lgkmcnt(0)
    s_barrier
    ds_read_b64_tr_b16 v[72:73], v105 offset:40960
    ds_read_b64_tr_b16 v[74:75], v105 offset:41472
    ds_read_b128 v[64:67], v104 offset:16384
    ds_read_b128 v[68:71], v104 offset:20480
    ds_read_b64_tr_b16 v[84:85], v105 offset:43008
    ds_read_b64_tr_b16 v[86:87], v105 offset:43520
    ds_read_b128 v[76:79], v106 offset:16384
    ds_read_b128 v[80:83], v106 offset:20480
    v_mfma_f32_32x32x16_bf16 v[8:23], v[48:51], v[40:43], v[8:23]
    v_mfma_f32_32x32x16_bf16 v[24:39], v[48:51], v[44:47], v[24:39]
    v_mfma_f32_32x32x16_bf16 v[8:23], v[60:63], v[52:55], v[8:23]
    v_mfma_f32_32x32x16_bf16 v[24:39], v[60:63], v[56:59], v[24:39]
    s_waitcnt lgkmcnt(0)
    s_barrier
    ds_read_b64_tr_b16 v[48:49], v105 offset:49152
    ds_read_b64_tr_b16 v[50:51], v105 offset:49664
    ds_read_b128 v[40:43], v104 offset:32768
    ds_read_b128 v[44:47], v104 offset:36864
    ds_read_b64_tr_b16 v[60:61], v105 offset:51200
    ds_read_b64_tr_b16 v[62:63], v105 offset:51712
    ds_read_b128 v[52:55], v106 offset:32768
    ds_read_b128 v[56:59], v106 offset:36864
    v_mfma_f32_32x32x16_bf16 v[8:23], v[72:75], v[64:67], v[8:23]
    v_mfma_f32_32x32x16_bf16 v[24:39], v[72:75], v[68:71], v[24:39]
    v_mfma_f32_32x32x16_bf16 v[8:23], v[84:87], v[76:79], v[8:23]
    v_mfma_f32_32x32x16_bf16 v[24:39], v[84:87], v[80:83], v[24:39]
    s_waitcnt lgkmcnt(0)
    s_barrier
    ds_read_b64_tr_b16 v[72:73], v105 offset:32768
    ds_read_b64_tr_b16 v[74:75], v105 offset:33280
    ds_read_b128 v[64:67], v104 offset:0
    ds_read_b128 v[68:71], v104 offset:4096
    ds_read_b64_tr_b16 v[84:85], v105 offset:34816
    ds_read_b64_tr_b16 v[86:87], v105 offset:35328
    ds_read_b128 v[76:79], v106 offset:0
    ds_read_b128 v[80:83], v106 offset:4096
    v_mfma_f32_32x32x16_bf16 v[8:23], v[48:51], v[40:43], v[8:23]
    v_mfma_f32_32x32x16_bf16 v[24:39], v[48:51], v[44:47], v[24:39]
    v_mfma_f32_32x32x16_bf16 v[8:23], v[60:63], v[52:55], v[8:23]
    v_mfma_f32_32x32x16_bf16 v[24:39], v[60:63], v[56:59], v[24:39]
    s_waitcnt lgkmcnt(0)
    s_barrier
    ds_read_b64_tr_b16 v[48:49], v105 offset:40960
    ds_read_b64_tr_b16 v[50:51], v105 offset:41472
    ds_read_b128 v[40:43], v104 offset:16384
    ds_read_b128 v[44:47], v104 offset:20480
    ds_read_b64_tr_b16 v[60:61], v105 offset:43008
    ds_read_b64_tr_b16 v[62:63], v105 offset:43520
    ds_read_b128 v[52:55], v106 offset:16384
    ds_read_b128 v[56:59], v106 offset:20480
    v_mfma_f32_32x32x16_bf16 v[8:23], v[72:75], v[64:67], v[8:23]
    v_mfma_f32_32x32x16_bf16 v[24:39], v[72:75], v[68:71], v[24:39]
    v_mfma_f32_32x32x16_bf16 v[8:23], v[84:87], v[76:79], v[8:23]
    v_mfma_f32_32x32x16_bf16 v[24:39], v[84:87], v[80:83], v[24:39]
    s_waitcnt lgkmcnt(0)
    s_barrier
    ds_read_b64_tr_b16 v[72:73], v105 offset:49152
    ds_read_b64_tr_b16 v[74:75], v105 offset:49664
    ds_read_b128 v[64:67], v104 offset:32768
    ds_read_b128 v[68:71], v104 offset:36864
    ds_read_b64_tr_b16 v[84:85], v105 offset:51200
    ds_read_b64_tr_b16 v[86:87], v105 offset:51712
    ds_read_b128 v[76:79], v106 offset:32768
    ds_read_b128 v[80:83], v106 offset:36864
    v_mfma_f32_32x32x16_bf16 v[8:23], v[48:51], v[40:43], v[8:23]
    v_mfma_f32_32x32x16_bf16 v[24:39], v[48:51], v[44:47], v[24:39]
    v_mfma_f32_32x32x16_bf16 v[8:23], v[60:63], v[52:55], v[8:23]
    v_mfma_f32_32x32x16_bf16 v[24:39], v[60:63], v[56:59], v[24:39]
    s_waitcnt lgkmcnt(0)
    s_barrier
    ds_read_b64_tr_b16 v[48:49], v105 offset:32768
    ds_read_b64_tr_b16 v[50:51], v105 offset:33280
    ds_read_b128 v[40:43], v104 offset:0
    ds_read_b128 v[44:47], v104 offset:4096
    ds_read_b64_tr_b16 v[60:61], v105 offset:34816
    ds_read_b64_tr_b16 v[62:63], v105 offset:35328
    ds_read_b128 v[52:55], v106 offset:0
    ds_read_b128 v[56:59], v106 offset:4096
    v_mfma_f32_32x32x16_bf16 v[8:23], v[72:75], v[64:67], v[8:23]
    v_mfma_f32_32x32x16_bf16 v[24:39], v[72:75], v[68:71], v[24:39]
    v_mfma_f32_32x32x16_bf16 v[8:23], v[84:87], v[76:79], v[8:23]
    v_mfma_f32_32x32x16_bf16 v[24:39], v[84:87], v[80:83], v[24:39]
    s_add_u32 s48, s48, 1
    s_cmp_lt_u32 s48, 4
    s_cbranch_scc1 DFT_loopT

    s_waitcnt lgkmcnt(0)
    s_barrier
    ds_read_b64_tr_b16 v[72:73], v105 offset:40960
    ds_read_b64_tr_b16 v[74:75], v105 offset:41472
    ds_read_b128 v[64:67], v104 offset:16384
    ds_read_b128 v[68:71], v104 offset:20480
    ds_read_b64_tr_b16 v[84:85], v105 offset:43008
    ds_read_b64_tr_b16 v[86:87], v105 offset:43520
    ds_read_b128 v[76:79], v106 offset:16384
    ds_read_b128 v[80:83], v106 offset:20480
    v_mfma_f32_32x32x16_bf16 v[8:23], v[48:51], v[40:43], v[8:23]
    v_mfma_f32_32x32x16_bf16 v[24:39], v[48:51], v[44:47], v[24:39]
    v_mfma_f32_32x32x16_bf16 v[8:23], v[60:63], v[52:55], v[8:23]
    v_mfma_f32_32x32x16_bf16 v[24:39], v[60:63], v[56:59], v[24:39]
    s_waitcnt lgkmcnt(0)
    s_barrier
    ds_read_b64_tr_b16 v[48:49], v105 offset:49152
    ds_read_b64_tr_b16 v[50:51], v105 offset:49664
    ds_read_b128 v[40:43], v104 offset:32768
    ds_read_b128 v[44:47], v104 offset:36864
    ds_read_b64_tr_b16 v[60:61], v105 offset:51200
    ds_read_b64_tr_b16 v[62:63], v105 offset:51712
    ds_read_b128 v[52:55], v106 offset:32768
    ds_read_b128 v[56:59], v106 offset:36864
    v_mfma_f32_32x32x16_bf16 v[8:23], v[72:75], v[64:67], v[8:23]
    v_mfma_f32_32x32x16_bf16 v[24:39], v[72:75], v[68:71], v[24:39]
    v_mfma_f32_32x32x16_bf16 v[8:23], v[84:87], v[76:79], v[8:23]
    v_mfma_f32_32x32x16_bf16 v[24:39], v[84:87], v[80:83], v[24:39]
    s_waitcnt lgkmcnt(0)
    s_barrier
    ds_read_b64_tr_b16 v[72:73], v105 offset:32768
    ds_read_b64_tr_b16 v[74:75], v105 offset:33280
    ds_read_b128 v[64:67], v104 offset:0
    ds_read_b128 v[68:71], v104 offset:4096
    ds_read_b64_tr_b16 v[84:85], v105 offset:34816
    ds_read_b64_tr_b16 v[86:87], v105 offset:35328
    ds_read_b128 v[76:79], v106 offset:0
    ds_read_b128 v[80:83], v106 offset:4096
    v_mfma_f32_32x32x16_bf16 v[8:23], v[48:51], v[40:43], v[8:23]
    v_mfma_f32_32x32x16_bf16 v[24:39], v[48:51], v[44:47], v[24:39]
    v_mfma_f32_32x32x16_bf16 v[8:23], v[60:63], v[52:55], v[8:23]
    v_mfma_f32_32x32x16_bf16 v[24:39], v[60:63], v[56:59], v[24:39]
    s_waitcnt lgkmcnt(0)
    s_barrier
    ds_read_b64_tr_b16 v[48:49], v105 offset:40960
    ds_read_b64_tr_b16 v[50:51], v105 offset:41472
    ds_read_b128 v[40:43], v104 offset:16384
    ds_read_b128 v[44:47], v104 offset:20480
    ds_read_b64_tr_b16 v[60:61], v105 offset:43008
    ds_read_b64_tr_b16 v[62:63], v105 offset:43520
    ds_read_b128 v[52:55], v106 offset:16384
    ds_read_b128 v[56:59], v106 offset:20480
    v_mfma_f32_32x32x16_bf16 v[8:23], v[72:75], v[64:67], v[8:23]
    v_mfma_f32_32x32x16_bf16 v[24:39], v[72:75], v[68:71], v[24:39]
    v_mfma_f32_32x32x16_bf16 v[8:23], v[84:87], v[76:79], v[8:23]
    v_mfma_f32_32x32x16_bf16 v[24:39], v[84:87], v[80:83], v[24:39]
    s_waitcnt lgkmcnt(0)
    s_barrier
    ds_read_b64_tr_b16 v[72:73], v105 offset:49152
    ds_read_b64_tr_b16 v[74:75], v105 offset:49664
    ds_read_b128 v[64:67], v104 offset:32768
    ds_read_b128 v[68:71], v104 offset:36864
    ds_read_b64_tr_b16 v[84:85], v105 offset:51200
    ds_read_b64_tr_b16 v[86:87], v105 offset:51712
    ds_read_b128 v[76:79], v106 offset:32768
    ds_read_b128 v[80:83], v106 offset:36864
    v_mfma_f32_32x32x16_bf16 v[8:23], v[48:51], v[40:43], v[8:23]
    v_mfma_f32_32x32x16_bf16 v[24:39], v[48:51], v[44:47], v[24:39]
    v_mfma_f32_32x32x16_bf16 v[8:23], v[60:63], v[52:55], v[8:23]
    v_mfma_f32_32x32x16_bf16 v[24:39], v[60:63], v[56:59], v[24:39]
    s_waitcnt lgkmcnt(0)
    s_barrier
    ds_read_b64_tr_b16 v[48:49], v105 offset:32768
    ds_read_b64_tr_b16 v[50:51], v105 offset:33280
    ds_read_b128 v[40:43], v104 offset:0
    ds_read_b128 v[44:47], v104 offset:4096
    ds_read_b64_tr_b16 v[60:61], v105 offset:34816
    ds_read_b64_tr_b16 v[62:63], v105 offset:35328
    ds_read_b128 v[52:55], v106 offset:0
    ds_read_b128 v[56:59], v106 offset:4096
    v_mfma_f32_32x32x16_bf16 v[8:23], v[72:75], v[64:67], v[8:23]
    v_mfma_f32_32x32x16_bf16 v[24:39], v[72:75], v[68:71], v[24:39]
    v_mfma_f32_32x32x16_bf16 v[8:23], v[84:87], v[76:79], v[8:23]
    v_mfma_f32_32x32x16_bf16 v[24:39], v[84:87], v[80:83], v[24:39]
    s_waitcnt lgkmcnt(0)
    s_barrier
    ds_read_b64_tr_b16 v[72:73], v105 offset:40960
    ds_read_b64_tr_b16 v[74:75], v105 offset:41472
    ds_read_b128 v[64:67], v104 offset:16384
    ds_read_b128 v[68:71], v104 offset:20480
    ds_read_b64_tr_b16 v[84:85], v105 offset:43008
    ds_read_b64_tr_b16 v[86:87], v105 offset:43520
    ds_read_b128 v[76:79], v106 offset:16384
    ds_read_b128 v[80:83], v106 offset:20480
    v_mfma_f32_32x32x16_bf16 v[8:23], v[48:51], v[40:43], v[8:23]
    v_mfma_f32_32x32x16_bf16 v[24:39], v[48:51], v[44:47], v[24:39]
    v_mfma_f32_32x32x16_bf16 v[8:23], v[60:63], v[52:55], v[8:23]
    v_mfma_f32_32x32x16_bf16 v[24:39], v[60:63], v[56:59], v[24:39]
DFT_red:
    s_setprio 2
    s_waitcnt lgkmcnt(0)

    s_cmp_ge_u32 s45, 2
    s_cbranch_scc1 DFT_hiB

    v_mfma_f32_32x32x16_bf16 v[24:39], v[72:75], v[68:71], v[24:39]
    v_mfma_f32_32x32x16_bf16 v[24:39], v[84:87], v[80:83], v[24:39]
    v_mfma_f32_32x32x16_bf16 v[8:23], v[72:75], v[64:67], v[8:23]
    v_mfma_f32_32x32x16_bf16 v[8:23], v[84:87], v[76:79], v[8:23]
    s_nop 7
    s_nop 1
    ds_write_b128 v113, v[24:27] offset:0
    ds_write_b128 v113, v[28:31] offset:1024
    ds_write_b128 v113, v[32:35] offset:2048
    ds_write_b128 v113, v[36:39] offset:3072
    s_waitcnt lgkmcnt(0)
    s_barrier
    ds_read_b128 v[40:43], v112 offset:0
    ds_read_b128 v[44:47], v112 offset:1024
    ds_read_b128 v[48:51], v112 offset:2048
    ds_read_b128 v[52:55], v112 offset:3072
    s_waitcnt lgkmcnt(2)
    v_add_f32 v8, v8, v40
    v_add_f32 v9, v9, v41
    v_add_f32 v10, v10, v42
    v_add_f32 v11, v11, v43
    v_add_f32 v12, v12, v44
    v_add_f32 v13, v13, v45
    v_add_f32 v14, v14, v46
    v_add_f32 v15, v15, v47
    v_cvt_pk_bf16_f32 v56, v8, v9
    v_cvt_pk_bf16_f32 v57, v10, v11
    v_cvt_pk_bf16_f32 v58, v12, v13
    v_cvt_pk_bf16_f32 v59, v14, v15
    v_xor_b32 v56, s49, v56
    v_xor_b32 v57, s49, v57
    v_xor_b32 v58, s49, v58
    v_xor_b32 v59, s49, v59
    buffer_store_dwordx4 v[56:59], v111, s[24:27], s58 offen offset:0 sc1
    s_waitcnt lgkmcnt(0)
    v_add_f32 v16, v16, v48
    v_add_f32 v17, v17, v49
    v_add_f32 v18, v18, v50
    v_add_f32 v19, v19, v51
    v_add_f32 v20, v20, v52
    v_add_f32 v21, v21, v53
    v_add_f32 v22, v22, v54
    v_add_f32 v23, v23, v55
    v_cvt_pk_bf16_f32 v60, v16, v17
    v_cvt_pk_bf16_f32 v61, v18, v19
    v_cvt_pk_bf16_f32 v62, v20, v21
    v_cvt_pk_bf16_f32 v63, v22, v23
    v_xor_b32 v60, s49, v60
    v_xor_b32 v61, s49, v61
    v_xor_b32 v62, s49, v62
    v_xor_b32 v63, s49, v63
    buffer_store_dwordx4 v[60:63], v111, s[24:27], s58 offen offset:512 sc1
    s_branch DFT_fin
DFT_hiB:
    v_mfma_f32_32x32x16_bf16 v[8:23], v[72:75], v[64:67], v[8:23]
    v_mfma_f32_32x32x16_bf16 v[8:23], v[84:87], v[76:79], v[8:23]
    v_mfma_f32_32x32x16_bf16 v[24:39], v[72:75], v[68:71], v[24:39]
    v_mfma_f32_32x32x16_bf16 v[24:39], v[84:87], v[80:83], v[24:39]
    s_nop 7
    s_nop 1
    ds_write_b128 v113, v[8:11] offset:0
    ds_write_b128 v113, v[12:15] offset:1024
    ds_write_b128 v113, v[16:19] offset:2048
    ds_write_b128 v113, v[20:23] offset:3072
    s_waitcnt lgkmcnt(0)
    s_barrier
    ds_read_b128 v[40:43], v112 offset:0
    ds_read_b128 v[44:47], v112 offset:1024
    ds_read_b128 v[48:51], v112 offset:2048
    ds_read_b128 v[52:55], v112 offset:3072
    s_waitcnt lgkmcnt(2)
    v_add_f32 v24, v24, v40
    v_add_f32 v25, v25, v41
    v_add_f32 v26, v26, v42
    v_add_f32 v27, v27, v43
    v_add_f32 v28, v28, v44
    v_add_f32 v29, v29, v45
    v_add_f32 v30, v30, v46
    v_add_f32 v31, v31, v47
    v_cvt_pk_bf16_f32 v56, v24, v25
    v_cvt_pk_bf16_f32 v57, v26, v27
    v_cvt_pk_bf16_f32 v58, v28, v29
    v_cvt_pk_bf16_f32 v59, v30, v31
    v_xor_b32 v56, s49, v56
    v_xor_b32 v57, s49, v57
    v_xor_b32 v58, s49, v58
    v_xor_b32 v59, s49, v59
    buffer_store_dwordx4 v[56:59], v111, s[24:27], s58 offen offset:0 sc1
    s_waitcnt lgkmcnt(0)
    v_add_f32 v32, v32, v48
    v_add_f32 v33, v33, v49
    v_add_f32 v34, v34, v50
    v_add_f32 v35, v35, v51
    v_add_f32 v36, v36, v52
    v_add_f32 v37, v37, v53
    v_add_f32 v38, v38, v54
    v_add_f32 v39, v39, v55
    v_cvt_pk_bf16_f32 v60, v32, v33
    v_cvt_pk_bf16_f32 v61, v34, v35
    v_cvt_pk_bf16_f32 v62, v36, v37
    v_cvt_pk_bf16_f32 v63, v38, v39
    v_xor_b32 v60, s49, v60
    v_xor_b32 v61, s49, v61
    v_xor_b32 v62, s49, v62
    v_xor_b32 v63, s49, v63
    buffer_store_dwordx4 v[60:63], v111, s[24:27], s58 offen offset:512 sc1
DFT_fin:
    s_memrealtime s[90:91]
    s_lshl_b32 s86, s3, 7
    s_add_u32 s86, s86, 16842752
    v_mov_b32 v4, 0
    s_waitcnt vmcnt(0) lgkmcnt(0)
    v_mov_b32 v2, s90
    v_mov_b32 v3, s91
    s_barrier
    s_cmp_lg_u32 s10, 7
    s_cbranch_scc1 SIG_skip5
    s_mov_b64 exec, 1
    buffer_store_dwordx2 v[2:3], v4, s[24:27], s86 offen sc1
    s_mov_b64 exec, -1

SIG_skip5:
    s_setprio 0
    s_cmp_lg_u32 s83, 0
    s_cbranch_scc1 HELP_NEXT

B_HID:
    s_sub_u32 s2, s82, 256
    s_mov_b32 s3, s2
    s_lshr_b32 s12, s2, 4
    s_and_b32 s11, s2, 15

    s_cmp_ge_u32 s10, 4
    s_cselect_b32 s16, s78, s76
    s_cselect_b32 s17, s79, s77
    s_mov_b32 s18, 401408
    s_mov_b32 s19, 0x00020000
    v_and_b32 v3, 15, v1
    v_lshrrev_b32 v4, 4, v1
    v_lshrrev_b32 v8, 3, v1
    v_mul_u32_u24 v8, 896, v8
    v_and_b32 v9, 7, v1
    v_xor_b32 v9, v9, v4
    s_and_b32 s14, s10, 1
    s_lshl_b32 s14, s14, 2
    v_xor_b32 v9, s14, v9
    v_lshl_add_u32 v8, v9, 4, v8
    s_and_b32 s14, s10, 3
    s_lshl_b32 s15, s12, 2
    s_add_u32 s15, s15, s14
    s_mul_i32 s15, s15, 7168
    s_lshl_b32 s28, s14, 10
    s_lshr_b32 s14, s10, 2
    s_mul_i32 s14, s14, 28672
    s_add_u32 s28, s28, s14
    s_lshl_b32 s13, s11, 3
    s_add_u32 s13, s13, s10
    s_mul_i32 s13, s13, 28672
    s_add_u32 s13, s13, 8388608

    s_add_u32 m0, s28, 0
    s_add_u32 s29, s15, 0
    buffer_load_dwordx4 v8, s[16:19], s29 offen lds

    s_add_u32 m0, s28, 4096
    s_add_u32 s29, s15, 128
    buffer_load_dwordx4 v8, s[16:19], s29 offen lds

    s_add_u32 m0, s28, 8192
    s_add_u32 s29, s15, 256
    buffer_load_dwordx4 v8, s[16:19], s29 offen lds

    s_add_u32 m0, s28, 12288
    s_add_u32 s29, s15, 384
    buffer_load_dwordx4 v8, s[16:19], s29 offen lds

    s_add_u32 m0, s28, 16384
    s_add_u32 s29, s15, 512
    buffer_load_dwordx4 v8, s[16:19], s29 offen lds

    s_add_u32 m0, s28, 20480
    s_add_u32 s29, s15, 640
    buffer_load_dwordx4 v8, s[16:19], s29 offen lds

    s_add_u32 m0, s28, 24576
    s_add_u32 s29, s15, 768
    buffer_load_dwordx4 v8, s[16:19], s29 offen lds

    v_bfe_u32 v3, v1, 1, 3
    v_min_u32 v3, 6, v3
    v_lshlrev_b32 v3, 5, v3
    v_and_b32 v4, 1, v1
    v_lshl_add_u32 v3, v4, 4, v3
    v_add_u32 v3, s11, v3
    v_lshlrev_b32 v3, 7, v3
    v_add_u32 v3, 16842752, v3

    s_sleep 12
    s_cmp_ge_u32 s10, 4
    s_cbranch_scc1 W_oth6
    s_lshl_b32 s91, s10, 2
    s_add_u32 s91, s91, 81904
    v_mov_b32 v2, s91
    s_mov_b32 s90, 0
    v_mov_b32 v4, 0
    s_cmp_ge_u32 s10, 1
    s_cbranch_scc1 W_ok6
    s_cmp_eq_u32 s83, 4
    s_cbranch_scc1 W_ok6
    v_mov_b32 v4, s85

W_spin6:
    buffer_load_dwordx2 v[6:7], v3, s[24:27], 0 offen sc1
    s_add_u32 s90, s90, 1
    s_waitcnt vmcnt(0)
    v_subrev_co_u32 v6, vcc, s84, v6
    v_subb_co_u32 v7, vcc, v7, v4, vcc
    v_lshrrev_b32 v6, 24, v6
    v_or_b32 v6, v6, v7
    v_cmpx_ne_u32 vcc, 0, v6
    s_nop 1
    s_cbranch_execz W_pass6
    s_sleep 6
    s_cmp_lt_u32 s90, 20000
    s_cbranch_scc1 W_spin6
    s_mov_b64 exec, -1
    v_mov_b32 v4, 1
    s_branch W_ok6

W_pass6:
    s_mov_b64 exec, -1
    v_mov_b32 v4, 0

W_ok6:
    s_mov_b64 exec, 1
    ds_write_b32 v2, v4
    s_mov_b64 exec, -1
    s_waitcnt lgkmcnt(0)

W_oth6:
    v_mov_b32 v2, 81904
    s_waitcnt vmcnt(0)
    s_barrier
    ds_read_b128 v[6:9], v2
    s_mov_b32 s83, 0
    s_waitcnt lgkmcnt(0)
    v_or3_b32 v6, v6, v7, v8
    v_or_b32 v6, v6, v9
    s_nop 0
    v_readfirstlane_b32 s91, v6
    s_cmp_lg_u32 s91, 0
    s_cbranch_scc1 HELP3

    v_and_b32 v3, 15, v1
    v_lshrrev_b32 v4, 4, v1

    buffer_load_dwordx4 v[40:43], v5, s[24:27], s13 offen offset:0
    buffer_load_dwordx4 v[44:47], v5, s[24:27], s13 offen offset:1024
    buffer_load_dwordx4 v[48:51], v5, s[24:27], s13 offen offset:2048
    buffer_load_dwordx4 v[52:55], v5, s[24:27], s13 offen offset:3072
    s_add_u32 s13, s13, 4096
    buffer_load_dwordx4 v[56:59], v5, s[24:27], s13 offen offset:0
    buffer_load_dwordx4 v[60:63], v5, s[24:27], s13 offen offset:1024
    buffer_load_dwordx4 v[64:67], v5, s[24:27], s13 offen offset:2048
    buffer_load_dwordx4 v[68:71], v5, s[24:27], s13 offen offset:3072
    s_add_u32 s13, s13, 4096
    buffer_load_dwordx4 v[72:75], v5, s[24:27], s13 offen offset:0
    buffer_load_dwordx4 v[76:79], v5, s[24:27], s13 offen offset:1024
    buffer_load_dwordx4 v[80:83], v5, s[24:27], s13 offen offset:2048
    buffer_load_dwordx4 v[84:87], v5, s[24:27], s13 offen offset:3072
    s_add_u32 s13, s13, 4096
    buffer_load_dwordx4 v[88:91], v5, s[24:27], s13 offen offset:0
    buffer_load_dwordx4 v[92:95], v5, s[24:27], s13 offen offset:1024
    buffer_load_dwordx4 v[96:99], v5, s[24:27], s13 offen offset:2048
    buffer_load_dwordx4 v[100:103], v5, s[24:27], s13 offen offset:3072
    s_add_u32 s13, s13, 4096
    buffer_load_dwordx4 v[104:107], v5, s[24:27], s13 offen offset:0
    buffer_load_dwordx4 v[108:111], v5, s[24:27], s13 offen offset:1024
    buffer_load_dwordx4 v[112:115], v5, s[24:27], s13 offen offset:2048
    buffer_load_dwordx4 v[116:119], v5, s[24:27], s13 offen offset:3072
    v_bfe_u32 v9, v1, 1, 3
    v_xor_b32 v9, v9, v4
    v_lshlrev_b32 v9, 4, v9
    v_lshl_add_u32 v9, v3, 7, v9
    v_xor_b32 v10, 64, v9
    s_lshl_b32 s14, s11, 7
    s_lshl_b32 s15, s10, 4
    s_add_u32 s14, s14, s15
    s_mul_i32 s14, s14, 1792
    s_lshl_b32 s15, s12, 6
    s_add_u32 s14, s14, s15
    s_add_u32 s14, s14, 896
    v_mul_u32_u24 v7, 1792, v3
    v_and_b32 v11, 1, v4
    v_lshl_add_u32 v7, v11, 5, v7
    v_lshrrev_b32 v11, 1, v4
    v_lshl_add_u32 v7, v11, 4, v7

    s_mov_b32 s32, s80
    s_mov_b32 s33, s81
    s_mov_b32 s34, 0x380000
    s_mov_b32 s35, 0x00020000
    ds_read_b128 v[24:27], v9 offset:0
    ds_read_b128 v[28:31], v9 offset:2048
    ds_read_b128 v[32:35], v10 offset:0
    ds_read_b128 v[36:39], v10 offset:2048
    s_waitcnt vmcnt(19) lgkmcnt(2)
    v_mfma_f32_16x16x32_bf16 v[16:19], v[24:27], v[40:43], 0
    v_mfma_f32_16x16x32_bf16 v[20:23], v[28:31], v[40:43], 0
    s_add_u32 s13, s13, 4096
    buffer_load_dwordx4 v[40:43], v5, s[24:27], s13 offen offset:0
    ds_read_b128 v[24:27], v9 offset:4096
    ds_read_b128 v[28:31], v9 offset:6144
    s_waitcnt vmcnt(19) lgkmcnt(2)
    v_mfma_f32_16x16x32_bf16 v[16:19], v[32:35], v[44:47], v[16:19]
    v_mfma_f32_16x16x32_bf16 v[20:23], v[36:39], v[44:47], v[20:23]
    buffer_load_dwordx4 v[44:47], v5, s[24:27], s13 offen offset:1024
    ds_read_b128 v[32:35], v10 offset:4096
    ds_read_b128 v[36:39], v10 offset:6144
    s_waitcnt vmcnt(19) lgkmcnt(2)
    v_mfma_f32_16x16x32_bf16 v[16:19], v[24:27], v[48:51], v[16:19]
    v_mfma_f32_16x16x32_bf16 v[20:23], v[28:31], v[48:51], v[20:23]
    buffer_load_dwordx4 v[48:51], v5, s[24:27], s13 offen offset:2048
    ds_read_b128 v[24:27], v9 offset:8192
    ds_read_b128 v[28:31], v9 offset:10240
    s_waitcnt vmcnt(19) lgkmcnt(2)
    v_mfma_f32_16x16x32_bf16 v[16:19], v[32:35], v[52:55], v[16:19]
    v_mfma_f32_16x16x32_bf16 v[20:23], v[36:39], v[52:55], v[20:23]
    buffer_load_dwordx4 v[52:55], v5, s[24:27], s13 offen offset:3072
    ds_read_b128 v[32:35], v10 offset:8192
    ds_read_b128 v[36:39], v10 offset:10240
    s_waitcnt vmcnt(19) lgkmcnt(2)
    v_mfma_f32_16x16x32_bf16 v[16:19], v[24:27], v[56:59], v[16:19]
    v_mfma_f32_16x16x32_bf16 v[20:23], v[28:31], v[56:59], v[20:23]
    s_add_u32 s13, s13, 4096
    buffer_load_dwordx4 v[56:59], v5, s[24:27], s13 offen offset:0
    ds_read_b128 v[24:27], v9 offset:12288
    ds_read_b128 v[28:31], v9 offset:14336
    s_waitcnt vmcnt(19) lgkmcnt(2)
    v_mfma_f32_16x16x32_bf16 v[16:19], v[32:35], v[60:63], v[16:19]
    v_mfma_f32_16x16x32_bf16 v[20:23], v[36:39], v[60:63], v[20:23]
    buffer_load_dwordx4 v[60:63], v5, s[24:27], s13 offen offset:1024
    ds_read_b128 v[32:35], v10 offset:12288
    ds_read_b128 v[36:39], v10 offset:14336
    s_waitcnt vmcnt(19) lgkmcnt(2)
    v_mfma_f32_16x16x32_bf16 v[16:19], v[24:27], v[64:67], v[16:19]
    v_mfma_f32_16x16x32_bf16 v[20:23], v[28:31], v[64:67], v[20:23]
    buffer_load_dwordx4 v[64:67], v5, s[24:27], s13 offen offset:2048
    ds_read_b128 v[24:27], v9 offset:16384
    ds_read_b128 v[28:31], v9 offset:18432
    s_waitcnt vmcnt(19) lgkmcnt(2)
    v_mfma_f32_16x16x32_bf16 v[16:19], v[32:35], v[68:71], v[16:19]
    v_mfma_f32_16x16x32_bf16 v[20:23], v[36:39], v[68:71], v[20:23]
    buffer_load_dwordx4 v[68:71], v5, s[24:27], s13 offen offset:3072
    ds_read_b128 v[32:35], v10 offset:16384
    ds_read_b128 v[36:39], v10 offset:18432
    s_waitcnt vmcnt(19) lgkmcnt(2)
    v_mfma_f32_16x16x32_bf16 v[16:19], v[24:27], v[72:75], v[16:19]
    v_mfma_f32_16x16x32_bf16 v[20:23], v[28:31], v[72:75], v[20:23]
    ds_read_b128 v[24:27], v9 offset:20480
    ds_read_b128 v[28:31], v9 offset:22528
    s_waitcnt vmcnt(18) lgkmcnt(2)
    v_mfma_f32_16x16x32_bf16 v[16:19], v[32:35], v[76:79], v[16:19]
    v_mfma_f32_16x16x32_bf16 v[20:23], v[36:39], v[76:79], v[20:23]
    ds_read_b128 v[32:35], v10 offset:20480
    ds_read_b128 v[36:39], v10 offset:22528
    s_waitcnt vmcnt(17) lgkmcnt(2)
    v_mfma_f32_16x16x32_bf16 v[16:19], v[24:27], v[80:83], v[16:19]
    v_mfma_f32_16x16x32_bf16 v[20:23], v[28:31], v[80:83], v[20:23]
    ds_read_b128 v[24:27], v9 offset:24576
    ds_read_b128 v[28:31], v9 offset:26624
    s_waitcnt vmcnt(16) lgkmcnt(2)
    v_mfma_f32_16x16x32_bf16 v[16:19], v[32:35], v[84:87], v[16:19]
    v_mfma_f32_16x16x32_bf16 v[20:23], v[36:39], v[84:87], v[20:23]
    ds_read_b128 v[32:35], v10 offset:24576
    ds_read_b128 v[36:39], v10 offset:26624
    s_waitcnt vmcnt(15) lgkmcnt(2)
    v_mfma_f32_16x16x32_bf16 v[16:19], v[24:27], v[88:91], v[16:19]
    v_mfma_f32_16x16x32_bf16 v[20:23], v[28:31], v[88:91], v[20:23]
    ds_read_b128 v[24:27], v9 offset:28672
    ds_read_b128 v[28:31], v9 offset:30720
    s_waitcnt vmcnt(14) lgkmcnt(2)
    v_mfma_f32_16x16x32_bf16 v[16:19], v[32:35], v[92:95], v[16:19]
    v_mfma_f32_16x16x32_bf16 v[20:23], v[36:39], v[92:95], v[20:23]
    ds_read_b128 v[32:35], v10 offset:28672
    ds_read_b128 v[36:39], v10 offset:30720
    s_waitcnt vmcnt(13) lgkmcnt(2)
    v_mfma_f32_16x16x32_bf16 v[16:19], v[24:27], v[96:99], v[16:19]
    v_mfma_f32_16x16x32_bf16 v[20:23], v[28:31], v[96:99], v[20:23]
    ds_read_b128 v[24:27], v9 offset:32768
    ds_read_b128 v[28:31], v9 offset:34816
    s_waitcnt vmcnt(12) lgkmcnt(2)
    v_mfma_f32_16x16x32_bf16 v[16:19], v[32:35], v[100:103], v[16:19]
    v_mfma_f32_16x16x32_bf16 v[20:23], v[36:39], v[100:103], v[20:23]
    ds_read_b128 v[32:35], v10 offset:32768
    ds_read_b128 v[36:39], v10 offset:34816
    s_waitcnt vmcnt(11) lgkmcnt(2)
    v_mfma_f32_16x16x32_bf16 v[16:19], v[24:27], v[104:107], v[16:19]
    v_mfma_f32_16x16x32_bf16 v[20:23], v[28:31], v[104:107], v[20:23]
    ds_read_b128 v[24:27], v9 offset:36864
    ds_read_b128 v[28:31], v9 offset:38912
    s_waitcnt vmcnt(10) lgkmcnt(2)
    v_mfma_f32_16x16x32_bf16 v[16:19], v[32:35], v[108:111], v[16:19]
    v_mfma_f32_16x16x32_bf16 v[20:23], v[36:39], v[108:111], v[20:23]
    ds_read_b128 v[32:35], v10 offset:36864
    ds_read_b128 v[36:39], v10 offset:38912
    s_waitcnt vmcnt(9) lgkmcnt(2)
    v_mfma_f32_16x16x32_bf16 v[16:19], v[24:27], v[112:115], v[16:19]
    v_mfma_f32_16x16x32_bf16 v[20:23], v[28:31], v[112:115], v[20:23]
    ds_read_b128 v[24:27], v9 offset:40960
    ds_read_b128 v[28:31], v9 offset:43008
    s_waitcnt vmcnt(8) lgkmcnt(2)
    v_mfma_f32_16x16x32_bf16 v[16:19], v[32:35], v[116:119], v[16:19]
    v_mfma_f32_16x16x32_bf16 v[20:23], v[36:39], v[116:119], v[20:23]
    ds_read_b128 v[32:35], v10 offset:40960
    ds_read_b128 v[36:39], v10 offset:43008
    s_waitcnt vmcnt(7) lgkmcnt(2)
    v_mfma_f32_16x16x32_bf16 v[16:19], v[24:27], v[40:43], v[16:19]
    v_mfma_f32_16x16x32_bf16 v[20:23], v[28:31], v[40:43], v[20:23]
    ds_read_b128 v[24:27], v9 offset:45056
    ds_read_b128 v[28:31], v9 offset:47104
    s_waitcnt vmcnt(6) lgkmcnt(2)
    v_mfma_f32_16x16x32_bf16 v[16:19], v[32:35], v[44:47], v[16:19]
    v_mfma_f32_16x16x32_bf16 v[20:23], v[36:39], v[44:47], v[20:23]
    ds_read_b128 v[32:35], v10 offset:45056
    ds_read_b128 v[36:39], v10 offset:47104
    s_waitcnt vmcnt(5) lgkmcnt(2)
    v_mfma_f32_16x16x32_bf16 v[16:19], v[24:27], v[48:51], v[16:19]
    v_mfma_f32_16x16x32_bf16 v[20:23], v[28:31], v[48:51], v[20:23]
    ds_read_b128 v[24:27], v9 offset:49152
    ds_read_b128 v[28:31], v9 offset:51200
    s_waitcnt vmcnt(4) lgkmcnt(2)
    v_mfma_f32_16x16x32_bf16 v[16:19], v[32:35], v[52:55], v[16:19]
    v_mfma_f32_16x16x32_bf16 v[20:23], v[36:39], v[52:55], v[20:23]
    ds_read_b128 v[32:35], v10 offset:49152
    ds_read_b128 v[36:39], v10 offset:51200
    s_waitcnt vmcnt(3) lgkmcnt(2)
    v_mfma_f32_16x16x32_bf16 v[16:19], v[24:27], v[56:59], v[16:19]
    v_mfma_f32_16x16x32_bf16 v[20:23], v[28:31], v[56:59], v[20:23]
    ds_read_b128 v[24:27], v9 offset:53248
    ds_read_b128 v[28:31], v9 offset:55296
    s_waitcnt vmcnt(2) lgkmcnt(2)
    v_mfma_f32_16x16x32_bf16 v[16:19], v[32:35], v[60:63], v[16:19]
    v_mfma_f32_16x16x32_bf16 v[20:23], v[36:39], v[60:63], v[20:23]
    ds_read_b128 v[32:35], v10 offset:53248
    ds_read_b128 v[36:39], v10 offset:55296
    s_waitcnt vmcnt(1) lgkmcnt(2)
    v_mfma_f32_16x16x32_bf16 v[16:19], v[24:27], v[64:67], v[16:19]
    v_mfma_f32_16x16x32_bf16 v[20:23], v[28:31], v[64:67], v[20:23]
    s_waitcnt vmcnt(0) lgkmcnt(0)
    v_mfma_f32_16x16x32_bf16 v[16:19], v[32:35], v[68:71], v[16:19]
    v_mfma_f32_16x16x32_bf16 v[20:23], v[36:39], v[68:71], v[20:23]
    s_nop 7
    v_cvt_pk_bf16_f32 v24, v16, v17
    v_cvt_pk_bf16_f32 v25, v18, v19
    v_cvt_pk_bf16_f32 v26, v20, v21
    v_cvt_pk_bf16_f32 v27, v22, v23
    s_nop 1
    v_permlane16_swap_b32 v24, v26
    v_permlane16_swap_b32 v25, v27
    s_nop 1
    buffer_store_dwordx4 v[24:27], v7, s[32:35], s14 offen sc0 sc1

    s_endpgm
ROLE_P:
    s_sub_u32 s3, s82, 480
P_dly:
    s_sleep 2
    s_memrealtime s[4:5]
    s_waitcnt lgkmcnt(0)
    s_sub_u32 s4, s4, s84
    s_cmp_lt_u32 s4, 50
    s_cbranch_scc1 P_dly
    s_and_b32 s11, s3, 7
    s_lshr_b32 s12, s3, 3
    s_mov_b64 s[16:17], s[70:71]
    s_mov_b32 s18, 1835008
    s_mov_b32 s19, 0x00020000
    v_lshlrev_b32 v6, 7, v1
    v_lshlrev_b32 v7, 12, v1
    s_lshl_b32 s13, s11, 2
    s_add_u32 s14, s13, s12
    s_mul_i32 s14, s14, 57344
    s_lshl_b32 s15, s10, 13
    s_add_u32 s14, s14, s15
    s_cmp_eq_u32 s10, 7
    s_cbranch_scc1 P_nox
    buffer_load_dword v8, v6, s[16:19], s14 offen

P_nox:
    s_cmp_ge_u32 s12, 2
    s_cselect_b32 s16, s74, s72
    s_cselect_b32 s17, s75, s73
    s_mov_b32 s18, 8388608
    s_and_b32 s14, s12, 1
    s_lshl_b32 s14, s14, 3
    s_add_u32 s14, s14, s11
    s_lshl_b32 s14, s14, 19
    s_and_b32 s15, s10, 1
    s_lshl_b32 s15, s15, 18
    s_add_u32 s14, s14, s15
    s_lshr_b32 s15, s10, 1
    s_add_u32 s13, s13, s15

    s_and_b32 s15, s13, 31
    s_lshl_b32 s15, s15, 7
    s_add_u32 s15, s15, s14
    s_add_u32 s13, s13, 4
    s_waitcnt vmcnt(0)

    buffer_load_dword v9, v7, s[16:19], s15 offen
    s_and_b32 s15, s13, 31
    s_lshl_b32 s15, s15, 7
    s_add_u32 s15, s15, s14
    s_add_u32 s13, s13, 4
    s_waitcnt vmcnt(0)

    buffer_load_dword v10, v7, s[16:19], s15 offen
    s_and_b32 s15, s13, 31
    s_lshl_b32 s15, s15, 7
    s_add_u32 s15, s15, s14
    s_add_u32 s13, s13, 4
    s_waitcnt vmcnt(0)

    buffer_load_dword v11, v7, s[16:19], s15 offen
    s_and_b32 s15, s13, 31
    s_lshl_b32 s15, s15, 7
    s_add_u32 s15, s15, s14
    s_add_u32 s13, s13, 4
    s_waitcnt vmcnt(0)

    buffer_load_dword v12, v7, s[16:19], s15 offen
    s_and_b32 s15, s13, 31
    s_lshl_b32 s15, s15, 7
    s_add_u32 s15, s15, s14
    s_add_u32 s13, s13, 4
    s_waitcnt vmcnt(0)

    buffer_load_dword v13, v7, s[16:19], s15 offen
    s_and_b32 s15, s13, 31
    s_lshl_b32 s15, s15, 7
    s_add_u32 s15, s15, s14
    s_add_u32 s13, s13, 4
    s_waitcnt vmcnt(0)

    buffer_load_dword v14, v7, s[16:19], s15 offen
    s_cmp_ge_u32 s10, 4
    s_cbranch_scc1 P_w
    s_andn2_b32 s14, s14, 262144
    s_add_u32 s20, s10, 48
    s_lshl_b32 s13, s11, 2

P_l2:
    s_lshr_b32 s15, s20, 1
    s_add_u32 s15, s15, s13
    s_and_b32 s15, s15, 31
    s_lshl_b32 s15, s15, 7
    s_add_u32 s15, s15, s14
    s_and_b32 s21, s20, 1
    s_lshl_b32 s21, s21, 18
    s_add_u32 s15, s15, s21
    s_add_u32 s20, s20, 4
    s_waitcnt vmcnt(0)
    buffer_load_dword v9, v7, s[16:19], s15 offen
    s_cmp_lt_u32 s20, 64
    s_cbranch_scc1 P_l2

P_x:
    s_waitcnt vmcnt(0)
    s_endpgm
P_w:
    s_sleep 8
    s_memrealtime s[4:5]
    s_waitcnt lgkmcnt(0)
    s_sub_u32 s4, s4, s84
    s_cmp_lt_u32 s4, 1700
    s_cbranch_scc1 P_w
    s_mul_i32 s13, s3, 5
    s_add_u32 s20, s13, 5
    s_add_u32 s13, s13, s10
    s_sub_u32 s13, s13, 4
    s_mov_b32 s18, 401408

P_lw:
    s_mov_b32 s14, s13
    s_cmp_ge_u32 s14, 49
    s_cselect_b32 s16, s78, s76
    s_cselect_b32 s17, s79, s77
    s_cselect_b32 s15, 49, 0
    s_sub_u32 s14, s14, s15
    s_cmp_ge_u32 s14, 49
    s_cselect_b32 s16, s68, s16
    s_cselect_b32 s17, s69, s17
    s_cselect_b32 s15, 49, 0
    s_sub_u32 s14, s14, s15
    s_lshl_b32 s14, s14, 13
    s_add_u32 s13, s13, 4
    s_waitcnt vmcnt(0)
    buffer_load_dword v20, v6, s[16:19], s14 offen
    s_cmp_lt_u32 s13, s20
    s_cbranch_scc1 P_lw
    s_waitcnt vmcnt(0)

    s_endpgm
    s_lshl_b32 s13, s12, 3
    s_add_u32 s13, s13, s10
    s_mov_b32 s18, 401408

    s_add_u32 s14, s13, 0
    s_cmp_ge_u32 s14, 49
    s_cselect_b32 s16, s78, s76
    s_cselect_b32 s17, s79, s77
    s_cselect_b32 s15, 49, 0
    s_sub_u32 s14, s14, s15
    s_cmp_ge_u32 s14, 49
    s_cselect_b32 s16, s68, s16
    s_cselect_b32 s17, s69, s17
    s_cselect_b32 s15, 49, 0
    s_sub_u32 s14, s14, s15
    s_lshl_b32 s14, s14, 13
    s_waitcnt vmcnt(0)
    buffer_load_dword v20, v6, s[16:19], s14 offen

    s_add_u32 s14, s13, 32
    s_cmp_ge_u32 s14, 49
    s_cselect_b32 s16, s78, s76
    s_cselect_b32 s17, s79, s77
    s_cselect_b32 s15, 49, 0
    s_sub_u32 s14, s14, s15
    s_cmp_ge_u32 s14, 49
    s_cselect_b32 s16, s68, s16
    s_cselect_b32 s17, s69, s17
    s_cselect_b32 s15, 49, 0
    s_sub_u32 s14, s14, s15
    s_lshl_b32 s14, s14, 13
    s_waitcnt vmcnt(0)
    buffer_load_dword v21, v6, s[16:19], s14 offen

    s_add_u32 s14, s13, 64
    s_cmp_ge_u32 s14, 49
    s_cselect_b32 s16, s78, s76
    s_cselect_b32 s17, s79, s77
    s_cselect_b32 s15, 49, 0
    s_sub_u32 s14, s14, s15
    s_cmp_ge_u32 s14, 49
    s_cselect_b32 s16, s68, s16
    s_cselect_b32 s17, s69, s17
    s_cselect_b32 s15, 49, 0
    s_sub_u32 s14, s14, s15
    s_lshl_b32 s14, s14, 13
    s_waitcnt vmcnt(0)
    buffer_load_dword v22, v6, s[16:19], s14 offen

    s_add_u32 s14, s13, 96
    s_cmp_ge_u32 s14, 49
    s_cselect_b32 s16, s78, s76
    s_cselect_b32 s17, s79, s77
    s_cselect_b32 s15, 49, 0
    s_sub_u32 s14, s14, s15
    s_cmp_ge_u32 s14, 49
    s_cselect_b32 s16, s68, s16
    s_cselect_b32 s17, s69, s17
    s_cselect_b32 s15, 49, 0
    s_sub_u32 s14, s14, s15
    s_lshl_b32 s14, s14, 13
    s_waitcnt vmcnt(0)
    buffer_load_dword v23, v6, s[16:19], s14 offen

    s_add_u32 s14, s13, 128
    s_cmp_ge_u32 s14, 49
    s_cselect_b32 s16, s78, s76
    s_cselect_b32 s17, s79, s77
    s_cselect_b32 s15, 49, 0
    s_sub_u32 s14, s14, s15
    s_cmp_ge_u32 s14, 49
    s_cselect_b32 s16, s68, s16
    s_cselect_b32 s17, s69, s17
    s_cselect_b32 s15, 49, 0
    s_sub_u32 s14, s14, s15
    s_lshl_b32 s14, s14, 13
    s_waitcnt vmcnt(0)
    buffer_load_dword v24, v6, s[16:19], s14 offen

    s_waitcnt vmcnt(0)
    s_endpgm
HELP1:
    s_mov_b32 s83, 1
    s_mov_b32 s88, 0
    s_mov_b32 s89, 224

    s_branch HELP_NEXT
HELP2:
    s_mov_b32 s83, 2
    s_mov_b32 s88, 0
    s_mov_b32 s89, 480

    s_branch HELP_NEXT
HELP3:
    s_mov_b32 s83, 3
    s_mov_b32 s88, 480
    s_mov_b32 s89, 704

HELP_NEXT:
    s_waitcnt vmcnt(0) lgkmcnt(0)
    s_barrier
    s_cmp_eq_u32 s88, s89
    s_cbranch_scc1 HELP_DONE
    s_mov_b32 s2, s88
    s_add_u32 s88, s88, 1
    s_cmp_lt_u32 s2, 224
    s_cbranch_scc1 QKV_ENTRY
    s_sub_u32 s2, s2, 224
    s_cmp_lt_u32 s2, 256
    s_cbranch_scc1 ATT_ENTRY
    s_sub_u32 s2, s2, 256
    s_branch DFT_ENTRY

HELP_DONE:
    s_mov_b32 s4, s83
    s_mov_b32 s83, 4
    s_cmp_eq_u32 s4, 1
    s_cbranch_scc1 A_ATT
    s_cmp_eq_u32 s4, 2
    s_cbranch_scc1 A_OUT
    s_branch B_HID

M_done:
    s_endpgm
.section .rodata,"a"
.p2align 6
.amdhsa_kernel main_kernel
  .amdhsa_next_free_vgpr 128
  .amdhsa_next_free_sgpr 102
  .amdhsa_accum_offset 128
  .amdhsa_group_segment_fixed_size 0
  .amdhsa_kernarg_size 88
  .amdhsa_user_sgpr_count 2
  .amdhsa_user_sgpr_kernarg_segment_ptr 1
  .amdhsa_system_sgpr_workgroup_id_x 1
.end_amdhsa_kernel
```
